```python
import torch

def _softmax(x, axis=-1):
    return torch.softmax(x, dim=axis)
def _gelu(x):
    return torch.nn.functional.gelu(x, approximate="tanh")
def _silu(x):
    return torch.nn.functional.silu(x)
def _sigmoid(x):
    return torch.sigmoid(x)
def _layernorm(x, axis=-1, eps=1e-5):
    m = x.mean(dim=axis, keepdim=True)
    v = x.var(dim=axis, keepdim=True, unbiased=False)
    return (x - m) / torch.sqrt(v + eps)
def _scatter_add(tgt, idx, src, axis=0):
    return tgt.clone().index_add_(axis, idx, src)
def _segment_sum(src, seg, n):
    out = torch.zeros((n,) + src.shape[1:], dtype=src.dtype)
    return out.index_add_(0, seg, src)
def _pad(x, pw):
    flat = tuple(v for pair in reversed(pw) for v in pair)
    return torch.nn.functional.pad(x, flat)

kernel_name = 'interleave_layers__spectral_fnet__spectral_fnet__prompt'

def setup_inputs():

    _w = (lambda a: (lambda t: t.to(torch.bfloat16) if t.is_floating_point() else t)(torch.as_tensor(a)))
    def _A_setup():
        B, S, D = 1, 2048, 1024
        ns = torch.arange(S)[:, None] * torch.arange(S)[None, :]
        nd = torch.arange(D)[:, None] * torch.arange(D)[None, :]
        Ws_re = torch.cos(-2.0 * torch.pi * ns / S).to(float)
        Ws_im = torch.sin(-2.0 * torch.pi * ns / S).to(float)
        Wd_re = torch.cos(-2.0 * torch.pi * nd / D).to(float)
        Wd_im = torch.sin(-2.0 * torch.pi * nd / D).to(float)
        return {
            "x": _w((lambda *s: torch.randn(*s, dtype=torch.bfloat16) * 0.05)(B, S, D)),
            "dft_seq_re": _w(Ws_re),
            "dft_seq_im": _w(Ws_im),
            "dft_hid_re": _w(Wd_re),
            "dft_hid_im": _w(Wd_im),
        }
    _A_in = _A_setup()

    def _B_setup():
        B, S, D = 1, 2048, 1024
        ns = torch.arange(S)[:, None] * torch.arange(S)[None, :]
        nd = torch.arange(D)[:, None] * torch.arange(D)[None, :]
        Ws_re = torch.cos(-2.0 * torch.pi * ns / S).to(float)
        Ws_im = torch.sin(-2.0 * torch.pi * ns / S).to(float)
        Wd_re = torch.cos(-2.0 * torch.pi * nd / D).to(float)
        Wd_im = torch.sin(-2.0 * torch.pi * nd / D).to(float)
        return {
            "x": _w((lambda *s: torch.randn(*s, dtype=torch.bfloat16) * 0.05)(B, S, D)),
            "dft_seq_re": _w(Ws_re),
            "dft_seq_im": _w(Ws_im),
            "dft_hid_re": _w(Wd_re),
            "dft_hid_im": _w(Wd_im),
        }
    _B_in = _B_setup()

    return {
        "A_x": _A_in["x"],
        "A_dft_seq_re": _A_in["dft_seq_re"],
        "A_dft_seq_im": _A_in["dft_seq_im"],
        "A_dft_hid_re": _A_in["dft_hid_re"],
        "A_dft_hid_im": _A_in["dft_hid_im"],
        "B_x": _B_in["x"],
        "B_dft_seq_re": _B_in["dft_seq_re"],
        "B_dft_seq_im": _B_in["dft_seq_im"],
        "B_dft_hid_re": _B_in["dft_hid_re"],
        "B_dft_hid_im": _B_in["dft_hid_im"],
    }

def reference(A_x, A_dft_seq_re, A_dft_seq_im, A_dft_hid_re, A_dft_hid_im, B_x, B_dft_seq_re, B_dft_seq_im, B_dft_hid_re, B_dft_hid_im):
    def _A_ref(x, dft_seq_re, dft_seq_im, dft_hid_re, dft_hid_im):
        a = torch.einsum("bsd,ed->bse", x, dft_hid_re)
        b = torch.einsum("bsd,ed->bse", x, dft_hid_im)
        y = torch.einsum("ts,bse->bte", dft_seq_re, a) - torch.einsum("ts,bse->bte", dft_seq_im, b)
        return y

    def _B_ref(x, dft_seq_re, dft_seq_im, dft_hid_re, dft_hid_im):
        a = torch.einsum("bsd,ed->bse", x, dft_hid_re)
        b = torch.einsum("bsd,ed->bse", x, dft_hid_im)
        y = torch.einsum("ts,bse->bte", dft_seq_re, a) - torch.einsum("ts,bse->bte", dft_seq_im, b)
        return y

    x = A_x
    x = x + _A_ref(_layernorm(x, axis=-1), A_dft_seq_re, A_dft_seq_im, A_dft_hid_re, A_dft_hid_im)
    x = x + _B_ref(_layernorm(x, axis=-1), B_dft_seq_re, B_dft_seq_im, B_dft_hid_re, B_dft_hid_im)
    x = x + _A_ref(_layernorm(x, axis=-1), A_dft_seq_re, A_dft_seq_im, A_dft_hid_re, A_dft_hid_im)
    x = x + _B_ref(_layernorm(x, axis=-1), B_dft_seq_re, B_dft_seq_im, B_dft_hid_re, B_dft_hid_im)
    return x
```

```asm
; @launch grid=(256,1,1) block=(320,1,1) lds=48384
.amdgcn_target "amdgcn-amd-amdhsa--gfx950"
.text
.globl interleave_layers__spectral_fnet__spectral_fnet__prompt_kernel
.p2align 8
.type interleave_layers__spectral_fnet__spectral_fnet__prompt_kernel,@function
interleave_layers__spectral_fnet__spectral_fnet__prompt_kernel:
    s_load_dwordx2 s[4:5], s[0:1], 0
    s_load_dwordx2 s[8:9], s[0:1], 96
    s_load_dwordx2 s[6:7], s[0:1], 80
    v_readfirstlane_b32 s12, v0
    s_cmp_ge_u32 s2, 256
    s_cbranch_scc1 L_end

    s_cmp_lt_u32 s12, 256
    s_cbranch_scc1 L_nopf
    s_setvskip s12, 8
    s_mov_b64 exec, 0
    s_bfe_u32 s86, s2, 0x50003
    s_mov_b32 s84, 0x11054540
    s_mov_b32 s85, 0x11040510
    s_lshl_b32 s87, s86, 1
    s_lshr_b64 s[84:85], s[84:85], s87
    s_mulk_i32 s86, 0x150
    s_and_b32 s84, s84, 3
    s_lshl_b32 s84, s84, 2
    s_sub_u32 s86, s86, s84
    s_add_u32 s86, s86, L_pf0-L_pc
    s_getpc_b64 s[84:85]
L_pc:
    s_add_u32 s84, s84, s86
    s_addc_u32 s85, s85, 0
    s_mov_b64 vcc, 0
    s_mov_b64 s[80:81], 0
    s_mov_b64 s[82:83], 0
    s_mov_b64 s[14:15], 0
    s_mov_b64 s[10:11], s[0:1]
    s_mov_b64 s[28:29], s[0:1]
    s_mov_b64 s[78:79], s[0:1]
    s_mov_b64 s[40:41], s[0:1]
    s_mov_b64 s[42:43], s[0:1]
    s_setpc_b64 s[84:85]
L_e0:
    s_endpgm
L_nopf:

    v_and_b32 v232, 127, v0
    s_lshr_b32 s13, s2, 6
    s_bfe_u32 s30, s2, 0x20001
    s_lshl2_add_u32 s13, s13, s30
    s_bfe_u32 s30, s2, 0x30003
    s_lshl3_add_u32 s13, s13, s30
    s_and_b32 s30, s2, 1
    s_lshl1_add_u32 s13, s13, s30
    s_lshr_b32 s47, s12, 7
    s_lshl1_add_u32 s13, s13, s47
    s_lshl_b32 s30, s13, 11
    s_sub_u32 s31, 0x200000, s30
    s_cmp_eq_u32 s13, 0
    s_cselect_b32 s31, 0x100000, s31
    v_lshl_add_u32 v182, v232, 4, s30
    v_lshl_add_u32 v183, v232, 4, s31
    v_and_b32 v220, 15, v0
    s_lshl_b32 s32, s2, 8
    v_lshrrev_b32 v235, 4, v0
    v_lshl_add_u32 v157, v220, 4, s32
    v_lshl_add_u32 v157, v235, 16, v157
    v_add_u32 v158, 0x100000, v157
    v_mov_b64 v[244:245], -1
    v_mov_b64 v[246:247], -1

    s_mov_b64 s[80:81], -1
    s_mov_b64 s[82:83], 1
    s_waitcnt lgkmcnt(0)
    global_load_dwordx4 v[184:187], v182, s[4:5]
    global_load_dwordx4 v[192:195], v183, s[4:5]
    s_add_u32 s10, s4, 0x200000
    s_addc_u32 s11, s5, 0
    global_load_dwordx4 v[188:191], v182, s[10:11]
    global_load_dwordx4 v[196:199], v183, s[10:11]
    s_add_u32 s28, s8, 0x3000000
    s_addc_u32 s29, s9, 0
    global_store_dwordx4 v157, v[244:247], s[8:9] sc1
    global_store_dwordx4 v158, v[244:247], s[8:9] sc1
    s_add_u32 s40, s8, 0x200000
    s_addc_u32 s41, s9, 0

    s_load_dword s17, s[28:29], 0x40000
L_pf0:
    v_lshlrev_b32 v233, 2, v0
    v_mov_b64 v[200:201], 0
    ds_write_b32 v233, v200 offset:47360
    s_mul_i32 s46, s47, 15392
    v_lshrrev_b32 v233, 3, v232
    v_add_u32 v233, v233, v232
    v_lshl_add_u32 v181, v233, 4, s46

    v_bfe_u32 v233, v0, 6, 1
    v_lshl_or_b32 v233, v233, 4, v220
    v_cvt_f32_u32 v240, v233
    v_and_b32 v234, 3, v235
    v_cvt_f32_u32 v241, v234
    v_mul_f32 v234, 0x3a800000, v240
    v_mul_f32 v241, 4.0, v241
    v_cvt_f32_u32 v237, s13
    v_mul_f32 v242, v241, v234
    v_fmamk_f32 v243, v237, 0x3a000000, v242
    v_add_f32 v243, 0xbe800000, v243
    v_mul_f32 v235, 0x41500000, v234

    v_cos_f32 v2, v242
    v_sin_f32 v10, v242
    v_cos_f32 v18, v243
    v_sin_f32 v26, v243
    v_pk_add_f32 v[242:243], v[242:243], v[234:235] op_sel_hi:[1,0]
    v_cos_f32 v3, v242
    v_sin_f32 v11, v242
    v_cos_f32 v19, v243
    v_sin_f32 v27, v243
    v_pk_add_f32 v[242:243], v[242:243], v[234:235] op_sel_hi:[1,0]
    v_cos_f32 v4, v242
    v_sin_f32 v12, v242
    v_cos_f32 v20, v243
    v_sin_f32 v28, v243
    v_pk_add_f32 v[242:243], v[242:243], v[234:235] op_sel_hi:[1,0]
    v_cos_f32 v5, v242
    v_sin_f32 v13, v242
    v_cos_f32 v21, v243
    v_sin_f32 v29, v243
    v_pk_add_f32 v[242:243], v[242:243], v[234:235] op_sel:[0,1] op_sel_hi:[1,1]
    v_cos_f32 v6, v242
    v_sin_f32 v14, v242
    v_cos_f32 v22, v243
    v_sin_f32 v30, v243
    v_pk_add_f32 v[242:243], v[242:243], v[234:235] op_sel_hi:[1,0]
    v_cos_f32 v7, v242
    v_sin_f32 v15, v242
    v_cos_f32 v23, v243
    v_sin_f32 v31, v243
    v_pk_add_f32 v[242:243], v[242:243], v[234:235] op_sel_hi:[1,0]
    v_cos_f32 v8, v242
    v_sin_f32 v16, v242
    v_cos_f32 v24, v243
    v_sin_f32 v32, v243
    v_pk_add_f32 v[242:243], v[242:243], v[234:235] op_sel_hi:[1,0]
    v_cos_f32 v9, v242
    v_sin_f32 v17, v242
    v_cos_f32 v25, v243
    v_sin_f32 v33, v243
    v_mul_f32 v234, 0x3d800000, v240
    v_mul_f32 v242, v241, v234
    v_fma_f32 v243, v234, 0.5, v242

    v_cos_f32 v232, v242
    v_cos_f32 v233, v243
    v_sin_f32 v236, v242
    v_sin_f32 v237, v243
    s_cbranch_execz L_e0
    v_cvt_pk_f16_f32 v34, v232, v233
    v_cvt_pk_f16_f32 v38, -v236, -v237
    v_pk_add_f32 v[242:243], v[242:243], v[234:235] op_sel_hi:[1,0]
    v_cos_f32 v232, v242
    v_cos_f32 v233, v243
    v_sin_f32 v236, v242
    v_sin_f32 v237, v243
    v_cvt_pk_f16_f32 v35, v232, v233
    v_cvt_pk_f16_f32 v39, -v236, -v237
    v_pk_add_f32 v[242:243], v[242:243], v[234:235] op_sel_hi:[1,0]
    v_cos_f32 v232, v242
    v_cos_f32 v233, v243
    v_sin_f32 v236, v242
    v_sin_f32 v237, v243
    v_cvt_pk_f16_f32 v36, v232, v233
    v_cvt_pk_f16_f32 v40, -v236, -v237
    v_pk_add_f32 v[242:243], v[242:243], v[234:235] op_sel_hi:[1,0]
    v_cos_f32 v232, v242
    v_cos_f32 v233, v243
    v_sin_f32 v236, v242
    v_sin_f32 v237, v243
    v_cvt_pk_f16_f32 v37, v232, v233
    v_cvt_pk_f16_f32 v41, -v236, -v237
    v_and_b32 v234, 3, v0
    v_bfe_u32 v242, v0, 2, 1
    v_lshl_or_b32 v234, v242, 3, v234
    v_bfe_u32 v242, v0, 3, 1
    v_lshl_or_b32 v234, v242, 2, v234
    v_cvt_f32_u32 v240, v234
    v_mul_f32 v235, 0x3d000000, v240
    v_add_f32 v234, v235, v235
    v_mul_f32 v242, v241, v235
    v_add_f32 v243, v242, v235
    v_lshlrev_b32 v238, 31, v0
    v_lshrrev_b32 v239, 16, v238
    v_or_b32 v238, v238, v239

    v_cos_f32 v232, v242
    v_sin_f32 v233, v242
    v_cos_f32 v236, v243
    v_sin_f32 v237, v243
    v_cvt_pk_f16_f32 v58, v232, v233
    v_cvt_pk_f16_f32 v62, -v233, v232
    v_cvt_pk_f16_f32 v59, v236, v237
    v_cvt_pk_f16_f32 v63, -v237, v236
    v_pk_add_f32 v[242:243], v[242:243], v[234:235] op_sel_hi:[1,0]
    v_cos_f32 v232, v242
    v_sin_f32 v233, v242
    v_cos_f32 v236, v243
    v_sin_f32 v237, v243
    v_cvt_pk_f16_f32 v60, v232, v233
    v_cvt_pk_f16_f32 v64, -v233, v232
    v_cvt_pk_f16_f32 v61, v236, v237
    v_cvt_pk_f16_f32 v65, -v237, v236
    v_xor_b32 v66, v238, v58
    v_xor_b32 v67, v238, v59
    v_xor_b32 v68, v238, v60
    v_xor_b32 v69, v238, v61
    v_xor_b32 v70, v238, v62
    s_cbranch_execz L_e0
    v_xor_b32 v71, v238, v63
    v_xor_b32 v72, v238, v64
    v_xor_b32 v73, v238, v65
    v_bfe_u32 v216, v0, 1, 2
    v_lshrrev_b32 v232, 5, v0
    v_lshl_or_b32 v216, v232, 2, v216
    v_lshrrev_b32 v217, 1, v0
    v_and_b32 v217, 12, v217
    v_and_b32 v239, 1, v0
    v_mul_u32_u24 v218, 15392, v239
    v_lshlrev_b32 v174, 5, v239
    v_cmp_ne_u32 vcc, 0, v216
    v_lshlrev_b32 v232, 3, v216
    v_and_b32 v232, 48, v232
    v_cndmask_b32_e64 v219, 14, 12, vcc
    v_lshl_add_u32 v232, v216, 6, v232
    v_add3_u32 v145, v232, v217, v218
    v_or_b32 v232, v216, v217
    v_cmp_eq_u32 vcc, 0, v232
    v_sub_u32 v233, 0, v216
    v_and_b32 v233, 31, v233
    v_lshlrev_b32 v234, 3, v233
    v_bfi_b32 v234, v234, 0, 48
    v_lshl_add_u32 v234, v233, 6, v234
    v_sub_u32 v233, v219, v217
    v_add3_u32 v148, v234, v233, v218
    v_add_u32 v232, 32, v145
    v_cndmask_b32 v144, v145, v232, vcc
    v_add_u32 v232, 2, v148
    v_cndmask_b32 v147, v232, v145, vcc
    v_xor_b32 v146, 16, v145
    v_xor_b32 v149, 16, v148
    v_mul_u32_u24 v232, 36, v217
    v_lshl_add_u32 v232, v216, 1, v232
    v_add_u32 v175, v232, v218
    v_sub_u32 v180, v218, v232
    v_add_u32 v180, 1616, v180
    v_lshl_add_u32 v179, v219, 3, v180
    v_add_u32 v232, 576, v179
    v_add_u32 v233, 1152, v175
    v_cndmask_b32 v176, v175, v233, vcc
    v_cndmask_b32 v177, v232, v175, vcc
    v_cndmask_b32 v178, v232, v233, vcc
    s_mov_b64 s[38:39], vcc
    v_and_b32 v232, 3, v0
    v_lshlrev_b32 v173, 5, v232
    v_bfe_u32 v232, v0, 3, 3
    v_lshl_or_b32 v173, v232, 2, v173
    v_lshrrev_b32 v233, 3, v0
    v_xor_b32 v233, v233, v0
    v_bfe_u32 v233, v233, 1, 2
    v_lshl_add_u32 v154, v220, 6, s46
    v_lshl_add_u32 v154, v233, 4, v154
    v_bfe_u32 v233, v0, 4, 1
    v_xor_b32 v232, v0, v233
    v_lshlrev_b32 v156, 4, v232
    v_bfe_u32 v232, v0, 2, 1
    v_xor_b32 v155, s47, v232
    v_lshlrev_b32 v155, 4, v155
    v_lshl_or_b32 v155, v232, 8, v155
    s_cbranch_execz L_e0
    v_lshl_or_b32 v155, v233, 12, v155

    v_bfe_u32 v242, v0, 0, 2
    v_lshl_or_b32 v155, v242, 5, v155
    v_bfe_u32 v242, v0, 3, 1
    v_lshl_or_b32 v155, v242, 7, v155
    v_bfe_u32 v242, v0, 5, 1
    v_lshl_or_b32 v155, v242, 11, v155
    v_bfe_u32 v242, v0, 6, 1
    v_lshl_or_b32 v155, v242, 9, v155
    v_mov_b64 v[202:203], 0
    v_mov_b64 v[204:205], 0
    v_mov_b64 v[206:207], 0
    v_mov_b64 v[208:209], 0
    v_mov_b64 v[210:211], 0
    v_mov_b64 v[212:213], 0
    v_mov_b64 v[214:215], 0
    v_mov_b64 v[106:107], 0
    v_mov_b64 v[108:109], 0
    v_mov_b64 v[110:111], 0
    v_mov_b64 v[112:113], 0
    v_mov_b64 v[114:115], 0
    v_mov_b64 v[116:117], 0
    v_mov_b64 v[118:119], 0
    v_mov_b64 v[120:121], 0
    v_mov_b64 v[150:151], 0
    v_mov_b64 v[152:153], 0
    v_and_b32 v239, 1, v0

    v_bfe_u32 v152, v0, 1, 1
    v_lshlrev_b32 v152, 8, v152
    v_bfe_u32 v242, v0, 2, 1
    v_lshl_or_b32 v152, v242, 11, v152
    v_bfe_u32 v242, v0, 3, 2
    v_lshl_or_b32 v152, v242, 9, v152
    v_bfe_u32 v242, v0, 5, 3
    v_lshl_or_b32 v152, v242, 12, v152
    s_and_b32 s32, s2, 7
    s_lshr_b32 s30, s2, 6
    s_lshl3_add_u32 s32, s30, s32
    s_lshl_b32 s32, s32, 16
    s_bfe_u32 s30, s2, 0x30003
    s_lshl_b32 s30, s30, 5
    s_or_b32 s32, s32, s30
    v_lshl_add_u32 v238, v239, 4, s32
    v_add_u32 v152, v238, v152
    v_add_u32 v153, 0x8000, v152

    v_bfe_u32 v150, v0, 1, 2
    v_lshlrev_b32 v150, 11, v150
    v_bfe_u32 v242, v0, 3, 1
    v_lshl_or_b32 v150, v242, 10, v150
    v_bfe_u32 v242, v0, 4, 1
    v_lshl_or_b32 v150, v242, 14, v150
    v_bfe_u32 v242, v0, 5, 1
    v_lshl_or_b32 v150, v242, 8, v150
    v_bfe_u32 v242, v0, 6, 1
    v_lshl_or_b32 v150, v242, 13, v150
    s_cbranch_execz L_e0
    v_bfe_u32 v242, v0, 7, 1
    v_lshl_or_b32 v150, v242, 9, v150
    v_add_u32 v150, v238, v150
    v_add_u32 v151, 0x8000, v150
    v_and_b32 v232, 7, v0
    v_bfe_u32 v242, v0, 3, 2
    v_lshl_or_b32 v232, v242, 5, v232
    v_bfe_u32 v242, v0, 5, 2
    v_lshl_or_b32 v232, v242, 3, v232
    v_bfe_u32 v242, v0, 7, 1
    v_lshl_or_b32 v232, v242, 7, v232
    v_and_b32 v242, 31, v232
    v_lshlrev_b32 v159, 7, v242
    v_lshrrev_b32 v242, 7, v232
    v_xor_b32 v242, v242, v232
    v_and_b32 v242, 7, v242
    v_lshl_add_u32 v159, v242, 4, v159
    v_bfe_u32 v242, v232, 5, 2
    v_lshl_add_u32 v159, v242, 2, v159
    v_sub_u32 v233, 768, v232
    v_cmp_eq_u32 vcc, 0, v232
    v_and_b32 v242, 31, v233
    v_lshlrev_b32 v162, 7, v242
    v_lshrrev_b32 v242, 7, v233
    v_xor_b32 v242, v242, v233
    v_and_b32 v242, 7, v242
    v_lshl_add_u32 v162, v242, 4, v162
    v_bfe_u32 v242, v233, 5, 2
    v_lshl_add_u32 v162, v242, 2, v162
    v_xor_b32 v161, 32, v159
    v_xor_b32 v233, 32, v162
    v_add_u32 v234, 64, v159
    v_cndmask_b32 v160, v233, v234, vcc
    s_lshl_b32 s32, s47, 12
    v_and_b32 v220, 15, v0
    v_bfe_u32 v236, v0, 4, 2
    v_and_b32 v234, 7, v0
    v_xor_b32 v233, v236, v234
    v_lshl_add_u32 v163, v220, 7, s32
    v_lshl_add_u32 v163, v233, 4, v163
    v_xor_b32 v164, 64, v163
    v_bfe_u32 v233, v0, 6, 1
    v_lshl_or_b32 v233, v233, 4, v220
    v_cvt_f32_u32 v240, v233
    v_cvt_f32_u32 v241, v236
    v_mul_f32 v241, 4.0, v241
    s_mov_b32 s18, 0x43000000
    s_mov_b32 s30, 0x80008000

    v_mul_f32 v235, 0x3d000000, v240
    v_add_f32 v234, v235, v235
    v_mul_f32 v242, v241, v235
    v_add_f32 v243, v242, v235
    v_lshlrev_b32 v238, 31, v0
    v_lshrrev_b32 v239, 16, v238
    v_or_b32 v238, v238, v239

    v_cos_f32 v232, v242
    v_sin_f32 v233, v242
    v_cos_f32 v236, v243
    v_sin_f32 v237, v243
    s_cbranch_execz L_e0
    v_cvt_pk_f16_f32 v42, v232, v233
    v_cvt_pk_f16_f32 v46, -v233, v232
    v_cvt_pk_f16_f32 v43, v236, v237
    v_cvt_pk_f16_f32 v47, -v237, v236
    v_pk_add_f32 v[242:243], v[242:243], v[234:235] op_sel_hi:[1,0]
    v_cos_f32 v232, v242
    v_sin_f32 v233, v242
    v_cos_f32 v236, v243
    v_sin_f32 v237, v243
    v_cvt_pk_f16_f32 v44, v232, v233
    v_cvt_pk_f16_f32 v48, -v233, v232
    v_cvt_pk_f16_f32 v45, v236, v237
    v_cvt_pk_f16_f32 v49, -v237, v236
    v_xor_b32 v50, v238, v42
    v_xor_b32 v51, v238, v43
    v_xor_b32 v52, v238, v44
    v_xor_b32 v53, v238, v45
    v_xor_b32 v54, v238, v46
    v_xor_b32 v55, v238, v47
    v_xor_b32 v56, v238, v48
    v_xor_b32 v57, v238, v49
    v_mov_b32 v74, v58
    v_xor_b32 v75, s30, v59
    v_mov_b32 v76, v60
    v_xor_b32 v77, s30, v61
    v_mov_b32 v78, v62
    v_xor_b32 v79, s30, v63
    v_mov_b32 v80, v64
    v_xor_b32 v81, s30, v65
    v_mov_b32 v82, v66
    v_xor_b32 v83, s30, v67
    v_mov_b32 v84, v68
    v_xor_b32 v85, s30, v69
    v_mov_b32 v86, v70
    v_xor_b32 v87, s30, v71
    v_mov_b32 v88, v72
    v_xor_b32 v89, s30, v73
    v_bfe_u32 v232, v0, 0, 4
    v_lshlrev_b32 v232, 1, v232
    v_bfe_u32 v242, v0, 5, 1
    v_lshl_or_b32 v232, v242, 8, v232
    v_bfe_u32 v242, v0, 6, 1
    v_lshl_or_b32 v232, v242, 5, v232
    v_bfe_u32 v233, v0, 4, 1
    v_cmp_eq_u32 vcc, 1, v233
    s_lshl_b32 s32, s47, 2
    v_lshl_add_u32 v233, v233, 3, s32
    v_mov_b32 v237, 1024
    v_mov_b32 v238, 0xfffffc00
    v_cndmask_b32 v237, v237, v238, vcc

    v_or_b32 v234, 0, v232
    v_sub_u32 v235, 0, v234
    v_cndmask_b32 v234, v234, v235, vcc
    v_bfe_u32 v235, v234, 0, 1
    v_lshlrev_b32 v235, 4, v235
    v_bfe_u32 v242, v234, 1, 1
    v_lshl_or_b32 v235, v242, 8, v235
    v_bfe_u32 v242, v234, 2, 3
    v_lshl_or_b32 v235, v242, 5, v235
    v_bfe_u32 v242, v234, 5, 4
    s_cbranch_execz L_e0
    v_lshl_or_b32 v235, v242, 9, v235
    v_bfe_u32 v242, v234, 1, 1
    v_lshlrev_b32 v242, 4, v242
    v_xor_b32 v235, v235, v242
    v_add_u32 v235, v235, v233
    v_and_b32 v165, 8191, v235
    v_add_u32 v235, v235, v237
    v_and_b32 v166, 8191, v235
    v_add_u32 v235, v235, v237
    v_and_b32 v167, 8191, v235
    v_add_u32 v235, v235, v237
    v_and_b32 v168, 8191, v235
    v_or_b32 v234, 1, v232
    v_sub_u32 v235, 0, v234
    v_cndmask_b32 v234, v234, v235, vcc
    v_bfe_u32 v235, v234, 0, 1
    v_lshlrev_b32 v235, 4, v235
    v_bfe_u32 v242, v234, 1, 1
    v_lshl_or_b32 v235, v242, 8, v235
    v_bfe_u32 v242, v234, 2, 3
    v_lshl_or_b32 v235, v242, 5, v235
    v_bfe_u32 v242, v234, 5, 4
    v_lshl_or_b32 v235, v242, 9, v235
    v_bfe_u32 v242, v234, 1, 1
    v_lshlrev_b32 v242, 4, v242
    v_xor_b32 v235, v235, v242
    v_add_u32 v235, v235, v233
    v_and_b32 v169, 8191, v235
    v_add_u32 v235, v235, v237
    v_and_b32 v170, 8191, v235
    v_add_u32 v235, v235, v237
    v_and_b32 v171, 8191, v235
    v_add_u32 v235, v235, v237
    v_and_b32 v172, 8191, v235
    s_mov_b32 s19, 0x3f27c5ac
    s_mov_b32 s20, 0x41800000
    s_mov_b32 s21, 0x41800000
    s_mov_b32 s22, 0x42000000
    s_mov_b32 s23, 0x42000000
    s_mov_b32 s24, 0x3e000000
    s_mov_b32 s25, 0x3e000000
    s_mov_b32 s26, 0x40000000
    s_mov_b32 s27, 0x40000000
    s_mov_b32 s44, 0x3b000000
    s_mov_b32 s45, 0x3b000000
    s_mov_b32 s34, 0x0f0f0f0f
    s_mov_b32 s35, 0x0f0f
    s_mov_b32 s36, 0x0f0f
    s_mov_b32 s37, 0x0f0f
    s_mov_b32 s14, 0
    s_cmp_eq_u32 s2, 0
    s_cbranch_execz L_e0
    s_cselect_b32 s15, 4, 0

    s_waitcnt vmcnt(5)
    ds_write_b128 v181, v[184:187] offset:6144
    s_waitcnt vmcnt(4)
    ds_write_b128 v181, v[192:195] offset:10752
    s_waitcnt vmcnt(3)
    ds_write_b128 v181, v[188:191] offset:8448
    s_waitcnt vmcnt(2)
    ds_write_b128 v181, v[196:199] offset:13056
    global_store_dwordx4 v157, v[244:247], s[40:41] sc1
    global_store_dwordx4 v158, v[244:247], s[40:41] sc1
    s_waitcnt vmcnt(2)
    s_cbranch_execz L_e0
    s_waitcnt lgkmcnt(0)
    s_barrier
    ds_read_u16_d16_hi v200, v176 offset:6144
    ds_read_u16_d16_hi v201, v176 offset:8448
    ds_read_u16_d16_hi v106, v178 offset:13056
    ds_read_u16_d16_hi v107, v178 offset:10752
    ds_read_u16_d16_hi v202, v177 offset:6144
    ds_read_u16_d16_hi v203, v177 offset:8448
    ds_read_u16_d16_hi v108, v175 offset:13056
    ds_read_u16_d16_hi v109, v175 offset:10752
    ds_read_u16_d16_hi v204, v175 offset:6208
    ds_read_u16_d16_hi v205, v175 offset:8512
    ds_read_u16_d16_hi v110, v180 offset:13664
    ds_read_u16_d16_hi v111, v180 offset:11360
    ds_read_u16_d16_hi v206, v180 offset:6752
    ds_read_u16_d16_hi v207, v180 offset:9056
    ds_read_u16_d16_hi v112, v175 offset:13120
    ds_read_u16_d16_hi v113, v175 offset:10816
    ds_read_u16_d16_hi v208, v175 offset:6720
    ds_read_u16_d16_hi v209, v175 offset:9024
    ds_read_u16_d16_hi v114, v179 offset:13056
    ds_read_u16_d16_hi v115, v179 offset:10752
    ds_read_u16_d16_hi v210, v179 offset:6144
    ds_read_u16_d16_hi v211, v179 offset:8448
    ds_read_u16_d16_hi v116, v175 offset:13632
    ds_read_u16_d16_hi v117, v175 offset:11328
    ds_read_u16_d16_hi v212, v175 offset:6784
    ds_read_u16_d16_hi v213, v175 offset:9088
    ds_read_u16_d16_hi v118, v180 offset:13088
    ds_read_u16_d16_hi v119, v180 offset:10784
    ds_read_u16_d16_hi v214, v180 offset:6176
    ds_read_u16_d16_hi v215, v180 offset:8480
    ds_read_u16_d16_hi v120, v175 offset:13696
    s_cbranch_execz L_e0
    ds_read_u16_d16_hi v121, v175 offset:11392
    s_mul_i32 s17, s17, 0x9E3779B1
    s_add_u32 s17, s17, 0x7F4A7C15
    s_cmp_lg_u32 s12, 0
    s_cbranch_scc1 L_ofp
    s_lshl_b32 s30, s2, 2
    v_mul_u32_u24 v251, 0x1100, v0
    v_add_u32 v251, s30, v251
    v_mov_b32 v252, s17
    s_mov_b64 exec, s[82:83]
    global_store_dword v251, v252, s[28:29] sc1

    s_mov_b64 exec, s[80:81]
L_ofp:

    s_cmp_eq_u32 s2, 0
    s_cbranch_scc1 L_w0pro
    s_waitcnt lgkmcnt(15)
    v_pk_add_f32 v[90:91], v[200:201], v[106:107]
    v_pk_add_f32 v[106:107], v[200:201], v[106:107] neg_lo:[0,1] neg_hi:[0,1]
    v_pk_mul_f32 v[184:185], v[106:107], v[106:107]
    s_waitcnt lgkmcnt(15)
    v_pk_add_f32 v[92:93], v[202:203], v[108:109]
    v_pk_add_f32 v[108:109], v[202:203], v[108:109] neg_lo:[0,1] neg_hi:[0,1]
    v_pk_fma_f32 v[184:185], v[108:109], v[108:109], v[184:185]
    v_pk_add_f32 v[188:189], v[106:107], v[108:109]
    s_waitcnt lgkmcnt(15)
    v_pk_add_f32 v[94:95], v[204:205], v[110:111]
    v_pk_add_f32 v[110:111], v[204:205], v[110:111] neg_lo:[0,1] neg_hi:[0,1]
    v_pk_fma_f32 v[184:185], v[110:111], v[110:111], v[184:185]
    v_pk_add_f32 v[188:189], v[188:189], v[110:111]
    s_waitcnt lgkmcnt(15)
    v_pk_add_f32 v[96:97], v[206:207], v[112:113]
    v_pk_add_f32 v[112:113], v[206:207], v[112:113] neg_lo:[0,1] neg_hi:[0,1]
    v_pk_fma_f32 v[184:185], v[112:113], v[112:113], v[184:185]
    v_pk_add_f32 v[188:189], v[188:189], v[112:113]
    s_waitcnt lgkmcnt(12)
    v_pk_add_f32 v[98:99], v[208:209], v[114:115]
    v_pk_add_f32 v[114:115], v[208:209], v[114:115] neg_lo:[0,1] neg_hi:[0,1]
    v_pk_fma_f32 v[184:185], v[114:115], v[114:115], v[184:185]
    v_pk_add_f32 v[188:189], v[188:189], v[114:115]
    s_waitcnt lgkmcnt(8)
    v_pk_add_f32 v[100:101], v[210:211], v[116:117]
    v_pk_add_f32 v[116:117], v[210:211], v[116:117] neg_lo:[0,1] neg_hi:[0,1]
    v_pk_fma_f32 v[184:185], v[116:117], v[116:117], v[184:185]
    v_pk_add_f32 v[188:189], v[188:189], v[116:117]
    s_waitcnt lgkmcnt(4)
    v_pk_add_f32 v[102:103], v[212:213], v[118:119]
    v_pk_add_f32 v[118:119], v[212:213], v[118:119] neg_lo:[0,1] neg_hi:[0,1]
    v_pk_fma_f32 v[184:185], v[118:119], v[118:119], v[184:185]
    v_pk_add_f32 v[188:189], v[188:189], v[118:119]
    s_waitcnt lgkmcnt(0)
    v_pk_add_f32 v[104:105], v[214:215], v[120:121]
    s_cbranch_execz L_e0
    v_pk_add_f32 v[120:121], v[214:215], v[120:121] neg_lo:[0,1] neg_hi:[0,1]
    v_pk_fma_f32 v[184:185], v[120:121], v[120:121], v[184:185]
    v_pk_add_f32 v[188:189], v[188:189], v[120:121]
    s_nop 1
    v_permlane32_swap_b32 v184, v188
    v_permlane32_swap_b32 v185, v189
    v_pk_add_f32 v[184:185], v[184:185], v[188:189]
    s_nop 1
    v_permlane16_swap_b32 v184, v186
    v_permlane16_swap_b32 v185, v187
    v_pk_add_f32 v[184:185], v[184:185], v[186:187]
    s_nop 1
    v_add_f32_dpp v188, v184, v184 row_ror:8 row_mask:0xf bank_mask:0x3
    s_nop 1
    v_add_f32_dpp v188, v185, v185 row_ror:8 row_mask:0xf bank_mask:0xc
    s_nop 1
    v_add_f32_dpp v189, v188, v188 row_shl:4 row_mask:0xf bank_mask:0xf bound_ctrl:0
    s_mov_b64 exec, s[36:37]
    ds_add_f32 v173, v189 offset:47872
    s_mov_b64 exec, s[80:81]
    s_branch L_xstats
L_xtop:
    global_load_dwordx4 v[192:195], v150, s[8:9]
    global_load_dwordx4 v[196:199], v151, s[8:9]
    s_waitcnt vmcnt(0)
    v_max3_u32 v184, v192, v193, v194
    v_max3_u32 v185, v195, v196, v197
    v_max3_u32 v184, v184, v198, v199
    v_max_u32 v184, v184, v185
    v_cmp_eq_u32 vcc, -1, v184

    s_cbranch_vccnz L_retryx
L_donex:
    s_add_u32 s8, s8, 0x200000
    s_addc_u32 s9, s9, 0
    v_fma_mix_f32 v90, v192, s18, v90 op_sel_hi:[1,0,0]
    v_fma_mix_f32 v91, v192, s18, v91 op_sel:[1,0,0] op_sel_hi:[1,0,0]
    v_fma_mix_f32 v92, v194, v128, v92 op_sel:[1,0,0] op_sel_hi:[1,0,0]
    v_fma_mix_f32 v93, v194, v128, v93 op_sel_hi:[1,0,0]
    v_fma_mix_f32 v94, v193, s18, v94 op_sel_hi:[1,0,0]
    v_fma_mix_f32 v95, v193, s18, v95 op_sel:[1,0,0] op_sel_hi:[1,0,0]
    v_fma_mix_f32 v96, v195, s18, v96 op_sel:[1,0,0] op_sel_hi:[1,0,0]
    v_fma_mix_f32 v97, v195, s18, v97 op_sel_hi:[1,0,0]
    v_fma_mix_f32 v98, v196, s18, v98 op_sel_hi:[1,0,0]
    v_fma_mix_f32 v99, v196, s18, v99 op_sel:[1,0,0] op_sel_hi:[1,0,0]
    v_fma_mix_f32 v100, v198, s18, v100 op_sel:[1,0,0] op_sel_hi:[1,0,0]
    v_fma_mix_f32 v101, v198, s18, v101 op_sel_hi:[1,0,0]
    v_fma_mix_f32 v102, v197, s18, v102 op_sel_hi:[1,0,0]
    v_fma_mix_f32 v103, v197, s18, v103 op_sel:[1,0,0] op_sel_hi:[1,0,0]
    v_fma_mix_f32 v104, v199, s18, v104 op_sel:[1,0,0] op_sel_hi:[1,0,0]
    v_fma_mix_f32 v105, v199, s18, v105 op_sel_hi:[1,0,0]
    s_cmp_ge_u32 s15, 4
    s_cbranch_scc1 L_slow
L_xstats:
    v_pk_mul_f32 v[184:185], v[90:91], v[90:91]
    v_pk_mul_f32 v[186:187], v[90:91], v[106:107]
    v_pk_add_f32 v[188:189], v[90:91], v[92:93]
    v_pk_fma_f32 v[184:185], v[92:93], v[92:93], v[184:185]
    v_pk_fma_f32 v[186:187], v[92:93], v[108:109], v[186:187]
    v_pk_fma_f32 v[184:185], v[94:95], v[94:95], v[184:185]
    v_pk_fma_f32 v[186:187], v[94:95], v[110:111], v[186:187]
    v_pk_add_f32 v[188:189], v[188:189], v[94:95]
    v_pk_fma_f32 v[184:185], v[96:97], v[96:97], v[184:185]
    v_pk_fma_f32 v[186:187], v[96:97], v[112:113], v[186:187]
    v_pk_add_f32 v[188:189], v[188:189], v[96:97]
    v_pk_fma_f32 v[184:185], v[98:99], v[98:99], v[184:185]
    v_pk_fma_f32 v[186:187], v[98:99], v[114:115], v[186:187]
    v_pk_add_f32 v[188:189], v[188:189], v[98:99]
    v_pk_fma_f32 v[184:185], v[100:101], v[100:101], v[184:185]
    v_pk_fma_f32 v[186:187], v[100:101], v[116:117], v[186:187]
    v_pk_add_f32 v[188:189], v[188:189], v[100:101]
    v_pk_fma_f32 v[184:185], v[102:103], v[102:103], v[184:185]
    v_pk_fma_f32 v[186:187], v[102:103], v[118:119], v[186:187]
    v_pk_add_f32 v[188:189], v[188:189], v[102:103]
    v_pk_fma_f32 v[184:185], v[104:105], v[104:105], v[184:185]
    v_pk_fma_f32 v[186:187], v[104:105], v[120:121], v[186:187]
    v_pk_add_f32 v[188:189], v[188:189], v[104:105]
    s_nop 1
    v_permlane32_swap_b32 v184, v188
    v_permlane32_swap_b32 v185, v189
    v_permlane32_swap_b32 v186, v190
    v_permlane32_swap_b32 v187, v191
    v_pk_add_f32 v[184:185], v[184:185], v[188:189]
    v_pk_add_f32 v[186:187], v[186:187], v[190:191]
    s_nop 1
    v_permlane16_swap_b32 v184, v186
    v_permlane16_swap_b32 v185, v187
    v_pk_add_f32 v[184:185], v[184:185], v[186:187]
    s_nop 1
    v_add_f32_dpp v188, v184, v184 row_ror:8 row_mask:0xf bank_mask:0x3
    s_nop 1
    v_add_f32_dpp v188, v185, v185 row_ror:8 row_mask:0xf bank_mask:0xc
    s_nop 1
    v_add_f32_dpp v189, v188, v188 row_shl:4 row_mask:0xf bank_mask:0xf bound_ctrl:0
    s_mov_b64 exec, s[34:35]
    ds_add_f32 v173, v189 offset:47360
    s_mov_b64 exec, s[80:81]
    s_cmp_eq_u32 s14, 0
    s_cbranch_execz L_e0
    s_waitcnt lgkmcnt(0)
    s_barrier
    s_cbranch_scc0 L_first1_ret
L_first1:
    ds_read_b64 v[184:185], v174 offset:47872
    ds_read_b64 v[192:193], v174 offset:47936
    ds_read_b64 v[188:189], v174 offset:47888
    ds_read_b64 v[196:197], v174 offset:47952
    v_mov_b32 v122, s19
    s_waitcnt lgkmcnt(0)
    v_pk_add_f32 v[184:185], v[184:185], v[192:193]
    v_pk_add_f32 v[188:189], v[188:189], v[196:197]
    v_pk_mul_f32 v[126:127], v[196:197], s[44:45]
    v_pk_fma_f32 v[122:123], v[184:185], s[20:21], v[122:123] op_sel_hi:[1,1,0]
    v_pk_mul_f32 v[124:125], v[188:189], s[24:25]
L_first1_ret:
    ds_read_b128 v[184:187], v174 offset:47360
    ds_read_b128 v[192:195], v174 offset:47424
    ds_read_b64 v[188:189], v174 offset:47376
    ds_read_b64 v[196:197], v174 offset:47440
    s_cmp_ge_u32 s14, 3
    s_cbranch_scc1 L_noclrxB
    s_add_u32 s40, s8, 0x400000
    s_addc_u32 s41, s9, 0
    v_mov_b64 v[244:245], -1
    v_mov_b64 v[246:247], -1

    global_store_dwordx4 v157, v[244:247], s[40:41] sc1
    global_store_dwordx4 v158, v[244:247], s[40:41] sc1
L_noclrxB:
    s_waitcnt lgkmcnt(2)
    v_pk_add_f32 v[184:185], v[184:185], v[192:193]
    v_pk_add_f32 v[186:187], v[186:187], v[194:195]
    v_pk_fma_f32 v[184:185], v[184:185], s[20:21], v[122:123]
    v_pk_fma_f32 v[200:201], v[186:187], s[22:23], v[184:185]
    v_pk_fma_f32 v[202:203], v[186:187], s[22:23], v[184:185] neg_lo:[1,0,0] neg_hi:[1,0,0]
    s_waitcnt lgkmcnt(0)
    v_pk_add_f32 v[188:189], v[188:189], v[196:197]
    v_pk_fma_f32 v[204:205], v[188:189], s[24:25], v[124:125]
    v_pk_fma_f32 v[206:207], v[188:189], s[24:25], v[124:125] neg_lo:[0,0,1] neg_hi:[0,0,1]
    v_pk_fma_f32 v[200:201], v[204:205], v[204:205], v[200:201] neg_lo:[1,0,0] neg_hi:[1,0,0]
    v_pk_fma_f32 v[202:203], v[206:207], v[206:207], v[202:203] neg_lo:[1,0,0] neg_hi:[1,0,0]
    v_max_f32 v200, s19, v200
    v_max_f32 v201, s19, v201
    v_max_f32 v202, s19, v202
    v_max_f32 v203, s19, v203
    v_rsq_f32 v200, v200
    v_rsq_f32 v201, v201
    v_rsq_f32 v202, v202
    v_rsq_f32 v203, v203
    v_pk_mul_f32 v[212:213], v[196:197], s[44:45]
    v_pk_add_f32 v[208:209], v[200:201], v[202:203]
    v_pk_add_f32 v[210:211], v[200:201], v[202:203] neg_lo:[0,1] neg_hi:[0,1]
    v_pk_mul_f32 v[212:213], v[212:213], v[208:209]
    v_pk_fma_f32 v[212:213], v[126:127], v[210:211], v[212:213]
    v_pk_fma_f32 v[216:217], v[210:211], v[106:107], v[212:213] neg_lo:[0,0,1] neg_hi:[0,0,1]
    v_pk_fma_f32 v[218:219], v[210:211], v[108:109], v[212:213] neg_lo:[0,0,1] neg_hi:[0,0,1]
    v_pk_fma_f32 v[220:221], v[210:211], v[110:111], v[212:213] neg_lo:[0,0,1] neg_hi:[0,0,1]
    v_pk_fma_f32 v[222:223], v[210:211], v[112:113], v[212:213] neg_lo:[0,0,1] neg_hi:[0,0,1]
    v_pk_fma_f32 v[224:225], v[210:211], v[114:115], v[212:213] neg_lo:[0,0,1] neg_hi:[0,0,1]
    v_pk_fma_f32 v[226:227], v[210:211], v[116:117], v[212:213] neg_lo:[0,0,1] neg_hi:[0,0,1]
    v_pk_fma_f32 v[228:229], v[210:211], v[118:119], v[212:213] neg_lo:[0,0,1] neg_hi:[0,0,1]
    v_pk_fma_f32 v[230:231], v[210:211], v[120:121], v[212:213] neg_lo:[0,0,1] neg_hi:[0,0,1]
    v_pk_fma_f32 v[216:217], v[208:209], v[90:91], v[216:217]
    v_pk_fma_f32 v[218:219], v[208:209], v[92:93], v[218:219]
    v_pk_fma_f32 v[220:221], v[208:209], v[94:95], v[220:221]
    v_pk_fma_f32 v[222:223], v[208:209], v[96:97], v[222:223]
    v_pk_fma_f32 v[224:225], v[208:209], v[98:99], v[224:225]
    v_pk_fma_f32 v[226:227], v[208:209], v[100:101], v[226:227]
    v_pk_fma_f32 v[228:229], v[208:209], v[102:103], v[228:229]
    v_pk_fma_f32 v[230:231], v[208:209], v[104:105], v[230:231]
    v_pk_add_f32 v[216:217], v[216:217], v[216:217] op_sel:[0,1] op_sel_hi:[0,1] neg_hi:[0,1]
    v_pk_add_f32 v[218:219], v[218:219], v[218:219] op_sel:[0,1] op_sel_hi:[0,1] neg_hi:[0,1]
    v_pk_add_f32 v[220:221], v[220:221], v[220:221] op_sel:[0,1] op_sel_hi:[0,1] neg_hi:[0,1]
    v_pk_add_f32 v[222:223], v[222:223], v[222:223] op_sel:[0,1] op_sel_hi:[0,1] neg_hi:[0,1]
    v_pk_add_f32 v[224:225], v[224:225], v[224:225] op_sel:[0,1] op_sel_hi:[0,1] neg_hi:[0,1]
    v_pk_add_f32 v[226:227], v[226:227], v[226:227] op_sel:[0,1] op_sel_hi:[0,1] neg_hi:[0,1]
    v_pk_add_f32 v[228:229], v[228:229], v[228:229] op_sel:[0,1] op_sel_hi:[0,1] neg_hi:[0,1]
    v_pk_add_f32 v[230:231], v[230:231], v[230:231] op_sel:[0,1] op_sel_hi:[0,1] neg_hi:[0,1]
    v_cvt_pk_f16_f32 v184, v216, v217
    ds_write_b16 v144, v184
    ds_write_b16_d16_hi v144, v184 offset:2048
    v_cvt_pk_f16_f32 v185, v218, v219
    ds_write_b16 v147, v185
    ds_write_b16_d16_hi v147, v185 offset:2048
    v_cvt_pk_f16_f32 v186, v220, v221
    ds_write_b16 v145, v186 offset:2
    ds_write_b16_d16_hi v145, v186 offset:2050
    v_cvt_pk_f16_f32 v187, v222, v223
    ds_write_b16 v148, v187
    ds_write_b16_d16_hi v148, v187 offset:2048
    v_cvt_pk_f16_f32 v188, v224, v225
    ds_write_b16 v146, v188
    ds_write_b16_d16_hi v146, v188 offset:2048
    v_cvt_pk_f16_f32 v189, v226, v227
    ds_write_b16 v149, v189 offset:2
    ds_write_b16_d16_hi v149, v189 offset:2050
    v_cvt_pk_f16_f32 v190, v228, v229
    ds_write_b16 v146, v190 offset:2
    ds_write_b16_d16_hi v146, v190 offset:2050
    v_cvt_pk_f16_f32 v191, v230, v231
    ds_write_b16 v149, v191
    ds_write_b16_d16_hi v149, v191 offset:2048
    s_cbranch_execz L_e0
    s_waitcnt lgkmcnt(0)
    s_barrier
L_xfft:
    ds_read_b128 v[184:187], v154
    ds_read_b128 v[188:191], v154 offset:2048
    ds_read_b128 v[192:195], v154 offset:1024
    ds_read_b128 v[196:199], v154 offset:3072
    s_cmp_lg_u32 s14, 0
    s_cbranch_scc1 L_noflx
    v_bfe_u32 v232, v152, 8, 7
    v_bfe_u32 v233, v152, 4, 1
    v_lshl_or_b32 v232, v233, 7, v232
    v_lshlrev_b32 v232, 2, v232
    global_load_dword v1, v232, s[28:29] sc1
L_noflx:
    s_waitcnt lgkmcnt(3)
    v_mfma_f32_16x16x32_f16 v[200:203], v[184:187], v[34:37], 0
    v_mfma_f32_16x16x32_f16 v[204:207], v[184:187], v[38:41], 0
    s_waitcnt lgkmcnt(2)
    v_mfma_f32_16x16x32_f16 v[208:211], v[188:191], v[34:37], 0
    v_mfma_f32_16x16x32_f16 v[212:215], v[188:191], v[38:41], 0
    s_waitcnt lgkmcnt(1)
    v_mfma_f32_16x16x32_f16 v[216:219], v[192:195], v[34:37], 0
    v_mfma_f32_16x16x32_f16 v[220:223], v[192:195], v[38:41], 0
    s_waitcnt lgkmcnt(0)
    v_mfma_f32_16x16x32_f16 v[224:227], v[196:199], v[34:37], 0
    v_mfma_f32_16x16x32_f16 v[228:231], v[196:199], v[38:41], 0
    v_pk_mul_f32 v[232:233], v[200:201], v[2:3]
    v_pk_mul_f32 v[234:235], v[204:205], v[2:3]
    v_pk_fma_f32 v[232:233], v[204:205], v[10:11], v[232:233]
    v_pk_fma_f32 v[234:235], v[200:201], v[10:11], v[234:235] neg_lo:[1,0,0] neg_hi:[1,0,0]
    v_pk_fma_f32 v[200:201], v[208:209], v[18:19], v[232:233]
    v_pk_fma_f32 v[204:205], v[212:213], v[18:19], v[234:235]
    v_pk_fma_f32 v[200:201], v[212:213], v[26:27], v[200:201]
    v_pk_fma_f32 v[204:205], v[208:209], v[26:27], v[204:205] neg_lo:[1,0,0] neg_hi:[1,0,0]
    v_pk_fma_f32 v[208:209], v[232:233], s[26:27], v[200:201] neg_lo:[0,0,1] neg_hi:[0,0,1]
    v_pk_fma_f32 v[212:213], v[234:235], s[26:27], v[204:205] neg_lo:[0,0,1] neg_hi:[0,0,1]
    v_pk_mul_f32 v[236:237], v[202:203], v[4:5]
    v_pk_mul_f32 v[238:239], v[206:207], v[4:5]
    v_pk_fma_f32 v[236:237], v[206:207], v[12:13], v[236:237]
    v_pk_fma_f32 v[238:239], v[202:203], v[12:13], v[238:239] neg_lo:[1,0,0] neg_hi:[1,0,0]
    v_pk_fma_f32 v[202:203], v[210:211], v[20:21], v[236:237]
    v_pk_fma_f32 v[206:207], v[214:215], v[20:21], v[238:239]
    v_pk_fma_f32 v[202:203], v[214:215], v[28:29], v[202:203]
    v_pk_fma_f32 v[206:207], v[210:211], v[28:29], v[206:207] neg_lo:[1,0,0] neg_hi:[1,0,0]
    v_pk_fma_f32 v[210:211], v[236:237], s[26:27], v[202:203] neg_lo:[0,0,1] neg_hi:[0,0,1]
    v_pk_fma_f32 v[214:215], v[238:239], s[26:27], v[206:207] neg_lo:[0,0,1] neg_hi:[0,0,1]
    v_cvt_pk_f16_f32 v184, v200, v204
    v_cvt_pk_f16_f32 v185, v201, v205
    v_cvt_pk_f16_f32 v186, v202, v206
    v_cvt_pk_f16_f32 v187, v203, v207
    v_cvt_pk_f16_f32 v192, v208, v212
    v_cvt_pk_f16_f32 v193, v209, v213
    v_cvt_pk_f16_f32 v194, v210, v214
    v_cvt_pk_f16_f32 v195, v211, v215
    v_pk_mul_f32 v[232:233], v[216:217], v[6:7]
    v_pk_mul_f32 v[234:235], v[220:221], v[6:7]
    v_pk_fma_f32 v[232:233], v[220:221], v[14:15], v[232:233]
    v_pk_fma_f32 v[234:235], v[216:217], v[14:15], v[234:235] neg_lo:[1,0,0] neg_hi:[1,0,0]
    v_pk_fma_f32 v[216:217], v[224:225], v[22:23], v[232:233]
    v_pk_fma_f32 v[220:221], v[228:229], v[22:23], v[234:235]
    v_pk_fma_f32 v[216:217], v[228:229], v[30:31], v[216:217]
    v_pk_fma_f32 v[220:221], v[224:225], v[30:31], v[220:221] neg_lo:[1,0,0] neg_hi:[1,0,0]
    v_pk_fma_f32 v[224:225], v[232:233], s[26:27], v[216:217] neg_lo:[0,0,1] neg_hi:[0,0,1]
    v_pk_fma_f32 v[228:229], v[234:235], s[26:27], v[220:221] neg_lo:[0,0,1] neg_hi:[0,0,1]
    v_pk_mul_f32 v[236:237], v[218:219], v[8:9]
    v_pk_mul_f32 v[238:239], v[222:223], v[8:9]
    v_pk_fma_f32 v[236:237], v[222:223], v[16:17], v[236:237]
    v_pk_fma_f32 v[238:239], v[218:219], v[16:17], v[238:239] neg_lo:[1,0,0] neg_hi:[1,0,0]
    v_pk_fma_f32 v[218:219], v[226:227], v[24:25], v[236:237]
    v_pk_fma_f32 v[222:223], v[230:231], v[24:25], v[238:239]
    v_pk_fma_f32 v[218:219], v[230:231], v[32:33], v[218:219]
    v_pk_fma_f32 v[222:223], v[226:227], v[32:33], v[222:223] neg_lo:[1,0,0] neg_hi:[1,0,0]
    v_pk_fma_f32 v[226:227], v[236:237], s[26:27], v[218:219] neg_lo:[0,0,1] neg_hi:[0,0,1]
    v_pk_fma_f32 v[230:231], v[238:239], s[26:27], v[222:223] neg_lo:[0,0,1] neg_hi:[0,0,1]
    v_cvt_pk_f16_f32 v188, v216, v220
    v_cvt_pk_f16_f32 v189, v217, v221
    v_cvt_pk_f16_f32 v190, v218, v222
    v_cvt_pk_f16_f32 v191, v219, v223
    v_cvt_pk_f16_f32 v196, v224, v228
    v_cvt_pk_f16_f32 v197, v225, v229
    v_cvt_pk_f16_f32 v198, v226, v230
    v_cvt_pk_f16_f32 v199, v227, v231
L_x2:
    v_mfma_f32_16x16x32_f16 v[232:235], v[58:61], v[184:187], 0
    v_mfma_f32_16x16x32_f16 v[236:239], v[62:65], v[184:187], 0
    v_mfma_f32_16x16x32_f16 v[240:243], v[58:61], v[192:195], 0
    v_mfma_f32_16x16x32_f16 v[244:247], v[62:65], v[192:195], 0
    v_mfma_f32_16x16x32_f16 v[232:235], v[66:69], v[188:191], v[232:235]
    v_mfma_f32_16x16x32_f16 v[236:239], v[70:73], v[188:191], v[236:239]
    v_mfma_f32_16x16x32_f16 v[240:243], v[66:69], v[196:199], v[240:243]
    v_mfma_f32_16x16x32_f16 v[244:247], v[70:73], v[196:199], v[244:247]
    s_cmp_eq_u32 s14, 0
    s_nop 4
    v_cvt_pk_f16_f32 v200, v232, v236
    v_cvt_pk_f16_f32 v201, v233, v237
    v_cvt_pk_f16_f32 v204, v234, v238
    v_cvt_pk_f16_f32 v205, v235, v239
    v_cvt_pk_f16_f32 v202, v240, -v244
    v_cvt_pk_f16_f32 v203, v241, -v245
    v_cvt_pk_f16_f32 v206, v242, -v246
    v_cvt_pk_f16_f32 v207, v243, -v247
    ds_write_b128 v155, v[200:203] offset:39168
    ds_write_b128 v155, v[204:207] offset:40192
    s_cbranch_execz L_e0
    s_waitcnt lgkmcnt(0)
    s_barrier
    ds_read_b128 v[184:187], v156 offset:39168
    ds_read_b128 v[188:191], v156 offset:43264
    s_waitcnt vmcnt(2) lgkmcnt(1)
    global_store_dwordx4 v157, v[184:187], s[8:9] sc1
    s_waitcnt lgkmcnt(0)
    global_store_dwordx4 v158, v[188:191], s[8:9] sc1
    s_cbranch_scc1 L_first2
    s_cmp_ge_u32 s15, 4
    s_cbranch_scc1 L_noack
L_first2_ret:
    s_waitcnt vmcnt(0)
L_noack:
    global_load_dwordx4 v[192:195], v152, s[8:9]
    global_load_dwordx4 v[196:199], v153, s[8:9]
    s_waitcnt vmcnt(0)
    v_max3_u32 v184, v192, v193, v194
    v_max3_u32 v185, v195, v196, v197
    v_max3_u32 v184, v184, v198, v199
    v_max_u32 v184, v184, v185
    v_cmp_eq_u32 vcc, -1, v184

    s_cbranch_vccnz L_retryy
L_doney:
    ds_write2st64_b32 v159, v192, v193 offset0:121 offset1:137
    ds_write2st64_b32 v160, v194, v195 offset0:121 offset1:137
    ds_write2st64_b32 v161, v196, v197 offset0:121 offset1:137
    ds_write2st64_b32 v162, v198, v199 offset0:121 offset1:137
    s_add_u32 s8, s8, 0x200000
    s_addc_u32 s9, s9, 0
    s_cbranch_execz L_e0
    s_waitcnt lgkmcnt(0)
    s_barrier
    ds_read_b128 v[184:187], v163 offset:30976
    ds_read_b128 v[188:191], v164 offset:30976
    ds_read_b128 v[192:195], v163 offset:33024
    ds_read_b128 v[196:199], v164 offset:33024
    v_add_u32 v173, 128, v173
    v_add_u32 v174, 128, v174
    s_cmp_ge_u32 s14, 3
    s_cbranch_scc1 L_noclrxD
    v_mov_b64 v[244:245], -1
    v_mov_b64 v[246:247], -1
    s_add_u32 s42, s8, 0x400000
    s_addc_u32 s43, s9, 0

    global_store_dwordx4 v157, v[244:247], s[42:43] sc1
    global_store_dwordx4 v158, v[244:247], s[42:43] sc1
L_noclrxD:
    s_waitcnt lgkmcnt(3)
    v_mfma_f32_16x16x32_f16 v[200:203], v[184:187], v[42:45], 0
    v_mfma_f32_16x16x32_f16 v[204:207], v[184:187], v[46:49], 0
    s_waitcnt lgkmcnt(2)
    v_mfma_f32_16x16x32_f16 v[200:203], v[188:191], v[50:53], v[200:203]
    v_mfma_f32_16x16x32_f16 v[204:207], v[188:191], v[54:57], v[204:207]
    s_waitcnt lgkmcnt(1)
    v_mfma_f32_16x16x32_f16 v[208:211], v[192:195], v[42:45], 0
    v_mfma_f32_16x16x32_f16 v[212:215], v[192:195], v[46:49], 0
    s_waitcnt lgkmcnt(0)
    v_mfma_f32_16x16x32_f16 v[208:211], v[196:199], v[50:53], v[208:211]
    v_mfma_f32_16x16x32_f16 v[212:215], v[196:199], v[54:57], v[212:215]
    s_nop 0
    v_pk_mul_f32 v[216:217], v[200:201], v[2:3]
    v_pk_mul_f32 v[220:221], v[204:205], v[2:3]
    v_pk_fma_f32 v[216:217], v[204:205], v[10:11], v[216:217]
    v_pk_fma_f32 v[220:221], v[200:201], v[10:11], v[220:221] neg_lo:[1,0,0] neg_hi:[1,0,0]
    v_pk_mul_f32 v[218:219], v[202:203], v[4:5]
    v_pk_mul_f32 v[222:223], v[206:207], v[4:5]
    v_pk_fma_f32 v[218:219], v[206:207], v[12:13], v[218:219]
    v_pk_fma_f32 v[222:223], v[202:203], v[12:13], v[222:223] neg_lo:[1,0,0] neg_hi:[1,0,0]
    v_cvt_pk_f16_f32 v184, v216, v220
    v_cvt_pk_f16_f32 v185, v217, v221
    v_cvt_pk_f16_f32 v186, v218, v222
    v_cvt_pk_f16_f32 v187, v219, v223
    v_pk_mul_f32 v[224:225], v[208:209], v[6:7]
    v_pk_mul_f32 v[228:229], v[212:213], v[6:7]
    v_pk_fma_f32 v[224:225], v[212:213], v[14:15], v[224:225]
    v_pk_fma_f32 v[228:229], v[208:209], v[14:15], v[228:229] neg_lo:[1,0,0] neg_hi:[1,0,0]
    v_pk_mul_f32 v[226:227], v[210:211], v[8:9]
    v_pk_mul_f32 v[230:231], v[214:215], v[8:9]
    v_pk_fma_f32 v[226:227], v[214:215], v[16:17], v[226:227]
    v_pk_fma_f32 v[230:231], v[210:211], v[16:17], v[230:231] neg_lo:[1,0,0] neg_hi:[1,0,0]
    v_cvt_pk_f16_f32 v188, v224, v228
    v_cvt_pk_f16_f32 v189, v225, v229
    v_cvt_pk_f16_f32 v190, v226, v230
    v_cvt_pk_f16_f32 v191, v227, v231
    v_mfma_f32_16x16x32_f16 v[232:235], v[58:61], v[184:187], 0
    v_mfma_f32_16x16x32_f16 v[236:239], v[74:77], v[184:187], 0
    v_mfma_f32_16x16x32_f16 v[240:243], v[62:65], v[184:187], 0
    v_mfma_f32_16x16x32_f16 v[244:247], v[78:81], v[184:187], 0
    v_mfma_f32_16x16x32_f16 v[232:235], v[66:69], v[188:191], v[232:235]
    v_mfma_f32_16x16x32_f16 v[236:239], v[82:85], v[188:191], v[236:239]
    v_mfma_f32_16x16x32_f16 v[240:243], v[70:73], v[188:191], v[240:243]
    v_mfma_f32_16x16x32_f16 v[244:247], v[86:89], v[188:191], v[244:247]
    s_nop 5
    v_cvt_pk_f16_f32 v200, v232, v236
    ds_write_b32 v165, v200 offset:39168
    v_cvt_pk_f16_f32 v201, v233, v237
    ds_write_b32 v166, v201 offset:39168
    v_cvt_pk_f16_f32 v202, v234, v238
    ds_write_b32 v167, v202 offset:39168
    v_cvt_pk_f16_f32 v203, v235, v239
    ds_write_b32 v168, v203 offset:39168
    v_cvt_pk_f16_f32 v204, v240, v244
    ds_write_b32 v169, v204 offset:39168
    v_cvt_pk_f16_f32 v205, v241, v245
    ds_write_b32 v170, v205 offset:39168
    v_cvt_pk_f16_f32 v206, v242, v246
    ds_write_b32 v171, v206 offset:39168
    v_cvt_pk_f16_f32 v207, v243, v247
    ds_write_b32 v172, v207 offset:39168
    s_cbranch_execz L_e0
    s_waitcnt lgkmcnt(0)
    s_barrier
    ds_read_b128 v[184:187], v156 offset:39168
    ds_read_b128 v[188:191], v156 offset:43264
    s_waitcnt lgkmcnt(1)
    global_store_dwordx4 v157, v[184:187], s[8:9] sc1
    s_waitcnt lgkmcnt(0)
    global_store_dwordx4 v158, v[188:191], s[8:9] sc1
    s_add_u32 s14, s14, 1
    s_add_u32 s15, s15, 1
    s_cmp_lt_u32 s14, 4
    s_cbranch_scc0 L_last
    s_waitcnt vmcnt(0)
    s_branch L_xtop
L_last:

    s_mov_b32 s60, 0x3f000000
    s_mov_b32 s61, 0x3f000000
    v_pk_mul_f32 v[106:107], v[106:107], s[60:61]
    v_pk_mul_f32 v[108:109], v[108:109], s[60:61]
    v_pk_mul_f32 v[110:111], v[110:111], s[60:61]
    v_pk_mul_f32 v[112:113], v[112:113], s[60:61]
    v_pk_mul_f32 v[114:115], v[114:115], s[60:61]
    v_pk_mul_f32 v[116:117], v[116:117], s[60:61]
    v_pk_mul_f32 v[118:119], v[118:119], s[60:61]
    v_pk_mul_f32 v[120:121], v[120:121], s[60:61]
    s_add_u32 s10, s6, 0x200000
    s_addc_u32 s11, s7, 0
    s_waitcnt vmcnt(0)
    s_branch L_xtop
L_retryx:
    s_mov_b32 s16, 0
L_rlx:
    s_mov_b64 exec, vcc
    global_load_dwordx4 v[192:195], v150, s[8:9] sc1
    global_load_dwordx4 v[196:199], v151, s[8:9] sc1
    s_add_u32 s16, s16, 1
    s_cmp_lt_u32 s16, 0x8000
    s_waitcnt vmcnt(0)
    v_max3_u32 v184, v192, v193, v194
    v_max3_u32 v185, v195, v196, v197
    v_max3_u32 v184, v184, v198, v199
    v_max_u32 v184, v184, v185
    v_cmp_eq_u32 vcc, -1, v184

    s_cbranch_scc0 L_rxx
    s_cbranch_vccnz L_rlx
L_rxx:
    s_mov_b64 exec, s[80:81]
    s_branch L_donex
L_retryy:
    s_mov_b32 s16, 0
L_rly:
    s_mov_b64 exec, vcc
    global_load_dwordx4 v[192:195], v152, s[8:9] sc1
    global_load_dwordx4 v[196:199], v153, s[8:9] sc1
    s_add_u32 s16, s16, 1
    s_cmp_lt_u32 s16, 0x8000
    s_waitcnt vmcnt(0)
    v_max3_u32 v184, v192, v193, v194
    v_max3_u32 v185, v195, v196, v197
    v_max3_u32 v184, v184, v198, v199
    v_max_u32 v184, v184, v185
    v_cmp_eq_u32 vcc, -1, v184

    s_cbranch_scc0 L_rxy
    s_cbranch_vccnz L_rly
L_rxy:
    s_mov_b64 exec, s[80:81]
    s_branch L_doney
L_first2:
    v_bfe_u32 v224, v152, 8, 7
    v_bfe_u32 v225, v152, 4, 1
    v_lshl_or_b32 v224, v225, 7, v224
    v_lshlrev_b32 v224, 2, v224
    s_mov_b64 s[78:79], s[28:29]
    s_waitcnt vmcnt(2)
    v_mov_b32 v225, v1
    v_cmp_ne_u32 vcc, s17, v1
    s_cbranch_vccz L_fok
    global_load_dword v225, v224, s[78:79] sc1
L_fok:
    v_mov_b32 v128, s18
    v_cndmask_b32_e64 v128, v128, 0, s[38:39]
    s_mov_b32 s16, 0
L_fpoll:
    s_waitcnt vmcnt(0)
    v_cmp_ne_u32 vcc, s17, v225
    s_cbranch_vccz L_first2_ret
    global_load_dword v225, v224, s[78:79] sc1
    s_add_u32 s16, s16, 1
    s_cmp_lt_u32 s16, 0x8000
    s_cbranch_scc1 L_fpoll
    s_branch L_first2_ret

L_slow:
    s_cmp_lt_u32 s14, 4
    s_cbranch_scc1 L_w0stats
    s_cmp_eq_u32 s2, 0
    s_cbranch_scc1 L_w0fin
    v_pk_fma_f32 v[200:201], v[90:91], s[60:61], v[106:107]
    v_pk_fma_f32 v[216:217], v[90:91], s[60:61], v[106:107] neg_lo:[0,0,1] neg_hi:[0,0,1]
    v_cvt_pk_bf16_f32 v184, v200, v201
    v_cvt_pk_bf16_f32 v192, v216, v217
    ds_write_b16 v176, v184 offset:6144
    s_cbranch_execz L_e0
    ds_write_b16_d16_hi v176, v184 offset:8448
    ds_write_b16 v178, v192 offset:13056
    ds_write_b16_d16_hi v178, v192 offset:10752
    v_pk_fma_f32 v[202:203], v[92:93], s[60:61], v[108:109]
    v_pk_fma_f32 v[218:219], v[92:93], s[60:61], v[108:109] neg_lo:[0,0,1] neg_hi:[0,0,1]
    v_cvt_pk_bf16_f32 v185, v202, v203
    v_cvt_pk_bf16_f32 v193, v218, v219
    ds_write_b16 v177, v185 offset:6144
    ds_write_b16_d16_hi v177, v185 offset:8448
    ds_write_b16 v175, v193 offset:13056
    ds_write_b16_d16_hi v175, v193 offset:10752
    v_pk_fma_f32 v[204:205], v[94:95], s[60:61], v[110:111]
    v_pk_fma_f32 v[220:221], v[94:95], s[60:61], v[110:111] neg_lo:[0,0,1] neg_hi:[0,0,1]
    v_cvt_pk_bf16_f32 v186, v204, v205
    v_cvt_pk_bf16_f32 v194, v220, v221
    ds_write_b16 v175, v186 offset:6208
    ds_write_b16_d16_hi v175, v186 offset:8512
    ds_write_b16 v180, v194 offset:13664
    ds_write_b16_d16_hi v180, v194 offset:11360
    v_pk_fma_f32 v[206:207], v[96:97], s[60:61], v[112:113]
    v_pk_fma_f32 v[222:223], v[96:97], s[60:61], v[112:113] neg_lo:[0,0,1] neg_hi:[0,0,1]
    v_cvt_pk_bf16_f32 v187, v206, v207
    v_cvt_pk_bf16_f32 v195, v222, v223
    ds_write_b16 v180, v187 offset:6752
    ds_write_b16_d16_hi v180, v187 offset:9056
    ds_write_b16 v175, v195 offset:13120
    ds_write_b16_d16_hi v175, v195 offset:10816
    v_pk_fma_f32 v[208:209], v[98:99], s[60:61], v[114:115]
    v_pk_fma_f32 v[224:225], v[98:99], s[60:61], v[114:115] neg_lo:[0,0,1] neg_hi:[0,0,1]
    v_cvt_pk_bf16_f32 v188, v208, v209
    v_cvt_pk_bf16_f32 v196, v224, v225
    ds_write_b16 v175, v188 offset:6720
    ds_write_b16_d16_hi v175, v188 offset:9024
    ds_write_b16 v179, v196 offset:13056
    ds_write_b16_d16_hi v179, v196 offset:10752
    v_pk_fma_f32 v[210:211], v[100:101], s[60:61], v[116:117]
    v_pk_fma_f32 v[226:227], v[100:101], s[60:61], v[116:117] neg_lo:[0,0,1] neg_hi:[0,0,1]
    v_cvt_pk_bf16_f32 v189, v210, v211
    v_cvt_pk_bf16_f32 v197, v226, v227
    ds_write_b16 v179, v189 offset:6144
    ds_write_b16_d16_hi v179, v189 offset:8448
    s_cbranch_execz L_e0
    ds_write_b16 v175, v197 offset:13632
    ds_write_b16_d16_hi v175, v197 offset:11328
    v_pk_fma_f32 v[212:213], v[102:103], s[60:61], v[118:119]
    v_pk_fma_f32 v[228:229], v[102:103], s[60:61], v[118:119] neg_lo:[0,0,1] neg_hi:[0,0,1]
    v_cvt_pk_bf16_f32 v190, v212, v213
    v_cvt_pk_bf16_f32 v198, v228, v229
    ds_write_b16 v175, v190 offset:6784
    ds_write_b16_d16_hi v175, v190 offset:9088
    ds_write_b16 v180, v198 offset:13088
    ds_write_b16_d16_hi v180, v198 offset:10784
    v_pk_fma_f32 v[214:215], v[104:105], s[60:61], v[120:121]
    v_pk_fma_f32 v[230:231], v[104:105], s[60:61], v[120:121] neg_lo:[0,0,1] neg_hi:[0,0,1]
    v_cvt_pk_bf16_f32 v191, v214, v215
    v_cvt_pk_bf16_f32 v199, v230, v231
    ds_write_b16 v180, v191 offset:6176
    ds_write_b16_d16_hi v180, v191 offset:8480
    ds_write_b16 v175, v199 offset:13696
    ds_write_b16_d16_hi v175, v199 offset:11392
L_fin2:
    s_cbranch_execz L_e0
    s_waitcnt lgkmcnt(0)
    s_barrier
    ds_read_b128 v[184:187], v181 offset:6144
    ds_read_b128 v[188:191], v181 offset:8448
    ds_read_b128 v[192:195], v181 offset:10752
    ds_read_b128 v[196:199], v181 offset:13056
    s_waitcnt lgkmcnt(3)
    global_store_dwordx4 v182, v[184:187], s[6:7] sc0 sc1
    s_waitcnt lgkmcnt(2)
    global_store_dwordx4 v182, v[188:191], s[10:11] sc0 sc1
    s_waitcnt lgkmcnt(1)
    global_store_dwordx4 v183, v[192:195], s[6:7] sc0 sc1
    s_waitcnt lgkmcnt(0)
    global_store_dwordx4 v183, v[196:199], s[10:11] sc0 sc1
L_end:
    s_endpgm
L_w0pro:
    s_mov_b32 s48, 0x55555555
    s_mov_b32 s49, 0x55555555
    s_not_b64 s[50:51], s[48:49]
    s_mov_b32 s35, 0x0f0f0f0f
    s_cmp_eq_u32 s12, 0
    s_cselect_b64 s[52:53], 1, 0
    s_andn2_b64 s[38:39], s[38:39], s[52:53]
    v_mov_b64 v[140:141], 0
    v_mov_b64 v[142:143], 0
    v_mov_b32 v232, 0
    s_mov_b64 exec, s[48:49]

    ds_read_u16_d16_hi v106, v178 offset:6144
    ds_read_u16_d16_hi v107, v178 offset:8448
    ds_read_u16_d16_hi v202, v178 offset:10752
    ds_read_u16_d16_hi v203, v176 offset:10752
    ds_read_u16_d16_hi v108, v176 offset:13056
    ds_read_u16_d16_hi v109, v178 offset:13056
    ds_read_u16_d16_hi v110, v180 offset:6752
    ds_read_u16_d16_hi v111, v180 offset:9056
    ds_read_u16_d16_hi v206, v180 offset:11360
    ds_read_u16_d16_hi v207, v175 offset:10816
    ds_read_u16_d16_hi v112, v175 offset:13120
    ds_read_u16_d16_hi v113, v180 offset:13664
    ds_read_u16_d16_hi v114, v179 offset:6144
    ds_read_u16_d16_hi v115, v179 offset:8448
    ds_read_u16_d16_hi v210, v179 offset:10752
    ds_read_u16_d16_hi v211, v175 offset:11328
    ds_read_u16_d16_hi v116, v175 offset:13632
    ds_read_u16_d16_hi v117, v179 offset:13056
    ds_read_u16_d16_hi v118, v180 offset:6176
    ds_read_u16_d16_hi v119, v180 offset:8480
    ds_read_u16_d16_hi v214, v180 offset:10784
    ds_read_u16_d16_hi v215, v175 offset:11392
    ds_read_u16_d16_hi v120, v175 offset:13696
    ds_read_u16_d16_hi v121, v180 offset:13088
    ds_read_u16_d16_hi v140, v232 offset:6144
    ds_read_u16_d16_hi v141, v232 offset:8448
    ds_read_u16_d16_hi v142, v232 offset:10752
    ds_read_u16_d16_hi v143, v232 offset:13056
    s_mov_b64 exec, s[80:81]
    s_mov_b32 s54, 0x40800000
    s_mov_b32 s55, 0x40800000
    s_mov_b32 s56, 0x41000000
    s_mov_b32 s57, 0xc1000000
    s_mov_b32 s58, 0x3d800000
    s_mov_b32 s59, 0x3d800000
    v_mov_b32 v130, s20
    v_mov_b32 v131, s22
    v_mov_b32 v132, s44
    v_mov_b32 v133, s19
    v_cndmask_b32_e64 v129, 1.0, 0.5, s[52:53]
    s_mov_b64 exec, s[48:49]
    v_mov_b32 v130, s56
    v_mov_b32 v131, 0
    v_mov_b32 v132, 0x3b800000
    v_mov_b32 v133, 0x3e27c5ac
    s_mov_b64 exec, s[80:81]
    s_waitcnt lgkmcnt(0)

    v_pk_add_f32 v[90:91], v[200:201], v[106:107]
    v_pk_add_f32 v[106:107], v[200:201], v[106:107] neg_lo:[0,1] neg_hi:[0,1]
    v_pk_add_f32 v[92:93], v[202:203], v[108:109]
    v_pk_add_f32 v[108:109], v[202:203], v[108:109] neg_lo:[0,1] neg_hi:[0,1]
    v_pk_add_f32 v[94:95], v[204:205], v[110:111]
    v_pk_add_f32 v[110:111], v[204:205], v[110:111] neg_lo:[0,1] neg_hi:[0,1]
    s_cbranch_execz L_e0
    v_pk_add_f32 v[96:97], v[206:207], v[112:113]
    v_pk_add_f32 v[112:113], v[206:207], v[112:113] neg_lo:[0,1] neg_hi:[0,1]
    v_pk_add_f32 v[98:99], v[208:209], v[114:115]
    v_pk_add_f32 v[114:115], v[208:209], v[114:115] neg_lo:[0,1] neg_hi:[0,1]
    v_pk_add_f32 v[100:101], v[210:211], v[116:117]
    v_pk_add_f32 v[116:117], v[210:211], v[116:117] neg_lo:[0,1] neg_hi:[0,1]
    v_pk_add_f32 v[102:103], v[212:213], v[118:119]
    v_pk_add_f32 v[118:119], v[212:213], v[118:119] neg_lo:[0,1] neg_hi:[0,1]
    v_pk_add_f32 v[104:105], v[214:215], v[120:121]
    v_pk_add_f32 v[120:121], v[214:215], v[120:121] neg_lo:[0,1] neg_hi:[0,1]
    v_pk_add_f32 v[140:141], v[140:141], v[140:141]
    v_pk_add_f32 v[142:143], v[142:143], v[142:143]
    v_pk_mul_f32 v[196:197], v[106:107], v[128:129] op_sel:[0,1] op_sel_hi:[1,1]
    v_pk_mul_f32 v[198:199], v[108:109], v[128:129] op_sel:[0,1] op_sel_hi:[1,1]
    v_pk_mul_f32 v[184:185], v[196:197], v[106:107]
    v_pk_mul_f32 v[192:193], v[198:199], v[108:109]
    v_pk_add_f32 v[188:189], v[196:197], v[110:111]
    v_pk_add_f32 v[190:191], v[198:199], v[112:113]
    v_pk_fma_f32 v[184:185], v[110:111], v[110:111], v[184:185]
    v_pk_fma_f32 v[192:193], v[112:113], v[112:113], v[192:193]
    v_pk_fma_f32 v[184:185], v[114:115], v[114:115], v[184:185]
    v_pk_fma_f32 v[192:193], v[116:117], v[116:117], v[192:193]
    v_pk_add_f32 v[188:189], v[188:189], v[114:115]
    v_pk_add_f32 v[190:191], v[190:191], v[116:117]
    v_pk_fma_f32 v[184:185], v[118:119], v[118:119], v[184:185]
    v_pk_fma_f32 v[192:193], v[120:121], v[120:121], v[192:193]
    v_pk_add_f32 v[188:189], v[188:189], v[118:119]
    v_pk_add_f32 v[190:191], v[190:191], v[120:121]
    s_mov_b64 exec, s[50:51]
    v_pk_add_f32 v[184:185], v[184:185], v[192:193]
    v_pk_add_f32 v[188:189], v[188:189], v[190:191]
    s_mov_b64 exec, s[48:49]
    v_add_f32 v186, v192, v193
    s_mov_b64 exec, s[80:81]
    v_permlane32_swap_b32 v184, v188
    v_permlane32_swap_b32 v185, v189
    v_permlane32_swap_b32 v186, v190
    v_permlane32_swap_b32 v187, v191
    v_pk_add_f32 v[184:185], v[184:185], v[188:189]
    v_pk_add_f32 v[186:187], v[186:187], v[190:191]
    s_nop 1
    v_permlane16_swap_b32 v184, v186
    v_permlane16_swap_b32 v185, v187
    v_pk_add_f32 v[184:185], v[184:185], v[186:187]
    s_nop 1
    v_add_f32_dpp v188, v184, v184 row_ror:8 row_mask:0xf bank_mask:0x3
    s_nop 1
    v_add_f32_dpp v188, v185, v185 row_ror:8 row_mask:0xf bank_mask:0xc
    s_nop 1
    v_add_f32_dpp v189, v188, v188 row_shl:4 row_mask:0xf bank_mask:0xf bound_ctrl:0
    s_mov_b64 exec, s[34:35]
    ds_add_f32 v173, v189 offset:47872
    s_mov_b64 exec, s[80:81]
L_w0stats:
    v_pk_mul_f32 v[196:197], v[90:91], v[128:129] op_sel:[0,1] op_sel_hi:[1,1]
    v_pk_mul_f32 v[198:199], v[92:93], v[128:129] op_sel:[0,1] op_sel_hi:[1,1]
    v_pk_mul_f32 v[184:185], v[196:197], v[90:91]
    v_pk_mul_f32 v[192:193], v[198:199], v[92:93]
    v_pk_mul_f32 v[186:187], v[196:197], v[106:107]
    v_pk_mul_f32 v[194:195], v[198:199], v[108:109]
    v_pk_add_f32 v[188:189], v[196:197], v[94:95]
    v_pk_add_f32 v[190:191], v[198:199], v[96:97]
    v_pk_fma_f32 v[184:185], v[94:95], v[94:95], v[184:185]
    v_pk_fma_f32 v[192:193], v[96:97], v[96:97], v[192:193]
    v_pk_fma_f32 v[186:187], v[94:95], v[110:111], v[186:187]
    v_pk_fma_f32 v[194:195], v[96:97], v[112:113], v[194:195]
    v_pk_fma_f32 v[184:185], v[98:99], v[98:99], v[184:185]
    v_pk_fma_f32 v[192:193], v[100:101], v[100:101], v[192:193]
    v_pk_fma_f32 v[186:187], v[98:99], v[114:115], v[186:187]
    v_pk_fma_f32 v[194:195], v[100:101], v[116:117], v[194:195]
    v_pk_add_f32 v[188:189], v[188:189], v[98:99]
    v_pk_add_f32 v[190:191], v[190:191], v[100:101]
    v_pk_fma_f32 v[184:185], v[102:103], v[102:103], v[184:185]
    v_pk_fma_f32 v[192:193], v[104:105], v[104:105], v[192:193]
    v_pk_fma_f32 v[186:187], v[102:103], v[118:119], v[186:187]
    v_pk_fma_f32 v[194:195], v[104:105], v[120:121], v[194:195]
    v_pk_add_f32 v[188:189], v[188:189], v[102:103]
    v_pk_add_f32 v[190:191], v[190:191], v[104:105]
    s_mov_b64 exec, s[50:51]
    v_pk_add_f32 v[184:185], v[184:185], v[192:193]
    v_pk_add_f32 v[188:189], v[188:189], v[190:191]
    v_pk_add_f32 v[186:187], v[186:187], v[194:195]
    s_mov_b64 exec, s[48:49]
    v_add_f32 v186, v192, v193
    v_add_f32 v187, v194, v195
    s_mov_b64 exec, s[80:81]
    v_permlane32_swap_b32 v184, v188
    v_permlane32_swap_b32 v185, v189
    v_permlane32_swap_b32 v186, v190
    v_permlane32_swap_b32 v187, v191
    v_pk_add_f32 v[184:185], v[184:185], v[188:189]
    v_pk_add_f32 v[186:187], v[186:187], v[190:191]
    s_nop 1
    v_permlane16_swap_b32 v184, v186
    v_permlane16_swap_b32 v185, v187
    v_pk_add_f32 v[184:185], v[184:185], v[186:187]
    s_nop 1
    v_add_f32_dpp v188, v184, v184 row_ror:8 row_mask:0xf bank_mask:0x3
    s_nop 1
    v_add_f32_dpp v188, v185, v185 row_ror:8 row_mask:0xf bank_mask:0xc
    s_nop 1
    v_add_f32_dpp v189, v188, v188 row_shl:4 row_mask:0xf bank_mask:0xf bound_ctrl:0
    s_mov_b64 exec, s[34:35]
    ds_add_f32 v173, v189 offset:47360
    s_mov_b64 exec, s[80:81]
    s_cmp_eq_u32 s14, 0
    s_cbranch_execz L_e0
    s_waitcnt lgkmcnt(0)
    s_barrier
    s_cbranch_scc0 L_w0first_ret
L_w0first:
    ds_read_b128 v[184:187], v174 offset:47872
    ds_read_b128 v[192:195], v174 offset:47936
    ds_read_b128 v[188:191], v174 offset:47888
    ds_read_b128 v[196:199], v174 offset:47952
    s_waitcnt lgkmcnt(0)
    v_pk_add_f32 v[184:185], v[184:185], v[192:193]
    v_add_f32 v186, v186, v194
    v_pk_add_f32 v[188:189], v[188:189], v[196:197]
    v_pk_add_f32 v[190:191], v[190:191], v[198:199]
    v_pk_fma_f32 v[122:123], v[184:185], v[130:131], v[132:133] op_sel:[0,0,1] op_sel_hi:[1,0,1]
    v_pk_mul_f32 v[124:125], v[188:189], s[24:25]
    v_pk_mul_f32 v[126:127], v[196:197], s[44:45]
    v_pk_mul_f32 v[138:139], v[196:197], s[44:45]
    s_mov_b64 exec, s[48:49]
    v_pk_mul_f32 v[200:201], v[140:141], s[54:55]
    v_pk_fma_f32 v[122:123], v[200:201], v[140:141], v[122:123]
    v_pk_mul_f32 v[124:125], v[140:141], s[58:59]
    v_pk_fma_f32 v[200:201], v[142:143], v[142:143], v[186:187] op_sel_hi:[1,1,0]
    v_pk_fma_f32 v[134:135], v[200:201], s[54:55], v[132:133] op_sel:[0,0,1] op_sel_hi:[1,1,1]
    v_pk_add_f32 v[190:191], v[190:191], v[190:191] op_sel:[0,1] op_sel_hi:[1,0]
    v_pk_add_f32 v[190:191], v[142:143], v[190:191] neg_hi:[0,1]
    v_pk_mul_f32 v[136:137], v[190:191], s[58:59]
    v_pk_add_f32 v[138:139], v[198:199], v[198:199] op_sel:[0,1] op_sel_hi:[1,0]
    v_pk_mul_f32 v[138:139], v[138:139], s[44:45]
    s_mov_b64 exec, s[80:81]
L_w0first_ret:
    ds_read_b128 v[184:187], v174 offset:47360
    ds_read_b128 v[192:195], v174 offset:47424
    ds_read_b128 v[188:191], v174 offset:47376
    ds_read_b128 v[196:199], v174 offset:47440
    s_cmp_ge_u32 s14, 3
    s_cbranch_scc1 L_noclrwB
    s_add_u32 s40, s8, 0x400000
    s_addc_u32 s41, s9, 0
    v_mov_b64 v[244:245], -1
    v_mov_b64 v[246:247], -1

    global_store_dwordx4 v157, v[244:247], s[40:41] sc1
    global_store_dwordx4 v158, v[244:247], s[40:41] sc1
L_noclrwB:
    s_waitcnt lgkmcnt(2)
    v_pk_add_f32 v[184:185], v[184:185], v[192:193]
    v_pk_add_f32 v[186:187], v[186:187], v[194:195]
    s_cbranch_execz L_e0
    v_pk_fma_f32 v[184:185], v[184:185], v[130:131], v[122:123] op_sel_hi:[1,0,1]
    v_pk_fma_f32 v[200:201], v[186:187], v[130:131], v[184:185] op_sel:[0,1,0] op_sel_hi:[1,1,1]
    v_pk_fma_f32 v[202:203], v[186:187], s[22:23], v[184:185] neg_lo:[1,0,0] neg_hi:[1,0,0]
    s_waitcnt lgkmcnt(0)
    v_pk_add_f32 v[188:189], v[188:189], v[196:197]
    v_pk_add_f32 v[190:191], v[190:191], v[198:199]
    v_pk_fma_f32 v[204:205], v[188:189], s[24:25], v[124:125]
    v_pk_fma_f32 v[206:207], v[188:189], s[24:25], v[124:125] neg_lo:[0,0,1] neg_hi:[0,0,1]
    v_pk_mul_f32 v[212:213], v[196:197], v[132:133] op_sel_hi:[1,0]
    v_pk_mul_f32 v[214:215], v[196:197], s[44:45]
    s_mov_b64 exec, s[48:49]
    v_pk_fma_f32 v[202:203], v[186:187], s[54:55], v[134:135] op_sel_hi:[0,1,1]
    v_pk_add_f32 v[190:191], v[190:191], v[190:191] op_sel:[0,1] op_sel_hi:[1,0]
    v_pk_add_f32 v[214:215], v[198:199], v[198:199] op_sel:[0,1] op_sel_hi:[1,0]
    v_pk_fma_f32 v[202:203], v[186:187], s[56:57], v[202:203] op_sel:[1,0,0] op_sel_hi:[1,1,1]
    v_pk_fma_f32 v[206:207], v[190:191], s[58:59], v[136:137]
    v_pk_mul_f32 v[214:215], v[214:215], s[44:45]
    s_mov_b64 exec, s[80:81]
    v_pk_fma_f32 v[200:201], v[204:205], v[204:205], v[200:201] neg_lo:[1,0,0] neg_hi:[1,0,0]
    v_pk_fma_f32 v[202:203], v[206:207], v[206:207], v[202:203] neg_lo:[1,0,0] neg_hi:[1,0,0]
    v_max_f32 v200, v133, v200
    v_max_f32 v201, v133, v201
    v_max_f32 v202, v133, v202
    v_max_f32 v203, v133, v203
    v_rsq_f32 v200, v200
    v_rsq_f32 v201, v201
    v_rsq_f32 v202, v202
    v_rsq_f32 v203, v203
    s_nop 0
    v_pk_add_f32 v[208:209], v[200:201], v[202:203]
    v_pk_add_f32 v[210:211], v[200:201], v[202:203] neg_lo:[0,1] neg_hi:[0,1]
    v_pk_add_f32 v[192:193], v[200:201], v[202:203]
    v_pk_add_f32 v[194:195], v[200:201], v[202:203] neg_lo:[0,1] neg_hi:[0,1]
    s_mov_b64 exec, s[48:49]
    v_mov_b64 v[208:209], v[200:201]
    v_mov_b64 v[210:211], 0
    v_pk_add_f32 v[192:193], v[202:203], v[202:203] op_sel:[0,1] op_sel_hi:[1,0]
    v_pk_add_f32 v[194:195], v[202:203], v[202:203] op_sel:[0,1] op_sel_hi:[0,1] neg_lo:[0,1] neg_hi:[0,1]
    s_mov_b64 exec, s[80:81]
    v_pk_mul_f32 v[212:213], v[212:213], v[208:209]
    v_pk_mul_f32 v[214:215], v[214:215], v[192:193]
    v_pk_fma_f32 v[212:213], v[126:127], v[210:211], v[212:213]
    v_pk_fma_f32 v[214:215], v[138:139], v[194:195], v[214:215]
    v_pk_fma_f32 v[216:217], v[210:211], v[106:107], v[212:213] neg_lo:[0,0,1] neg_hi:[0,0,1]
    v_pk_fma_f32 v[218:219], v[194:195], v[108:109], v[214:215] neg_lo:[0,0,1] neg_hi:[0,0,1]
    v_pk_fma_f32 v[220:221], v[210:211], v[110:111], v[212:213] neg_lo:[0,0,1] neg_hi:[0,0,1]
    v_pk_fma_f32 v[222:223], v[194:195], v[112:113], v[214:215] neg_lo:[0,0,1] neg_hi:[0,0,1]
    v_pk_fma_f32 v[224:225], v[210:211], v[114:115], v[212:213] neg_lo:[0,0,1] neg_hi:[0,0,1]
    v_pk_fma_f32 v[226:227], v[194:195], v[116:117], v[214:215] neg_lo:[0,0,1] neg_hi:[0,0,1]
    v_pk_fma_f32 v[228:229], v[210:211], v[118:119], v[212:213] neg_lo:[0,0,1] neg_hi:[0,0,1]
    s_cbranch_execz L_e0
    v_pk_fma_f32 v[230:231], v[194:195], v[120:121], v[214:215] neg_lo:[0,0,1] neg_hi:[0,0,1]
    v_pk_fma_f32 v[216:217], v[208:209], v[90:91], v[216:217]
    v_pk_fma_f32 v[218:219], v[192:193], v[92:93], v[218:219]
    v_pk_fma_f32 v[220:221], v[208:209], v[94:95], v[220:221]
    v_pk_fma_f32 v[222:223], v[192:193], v[96:97], v[222:223]
    v_pk_fma_f32 v[224:225], v[208:209], v[98:99], v[224:225]
    v_pk_fma_f32 v[226:227], v[192:193], v[100:101], v[226:227]
    v_pk_fma_f32 v[228:229], v[208:209], v[102:103], v[228:229]
    v_pk_fma_f32 v[230:231], v[192:193], v[104:105], v[230:231]
    v_pk_add_f32 v[216:217], v[216:217], v[216:217] op_sel:[0,1] op_sel_hi:[0,1] neg_hi:[0,1]
    v_pk_add_f32 v[220:221], v[220:221], v[220:221] op_sel:[0,1] op_sel_hi:[0,1] neg_hi:[0,1]
    v_pk_add_f32 v[224:225], v[224:225], v[224:225] op_sel:[0,1] op_sel_hi:[0,1] neg_hi:[0,1]
    v_pk_add_f32 v[228:229], v[228:229], v[228:229] op_sel:[0,1] op_sel_hi:[0,1] neg_hi:[0,1]
    v_cvt_pk_f16_f32 v184, v216, v217
    ds_write_b16 v144, v184
    ds_write_b16_d16_hi v144, v184 offset:2048
    v_cvt_pk_f16_f32 v186, v220, v221
    ds_write_b16 v145, v186 offset:2
    ds_write_b16_d16_hi v145, v186 offset:2050
    v_cvt_pk_f16_f32 v188, v224, v225
    ds_write_b16 v146, v188
    ds_write_b16_d16_hi v146, v188 offset:2048
    v_cvt_pk_f16_f32 v190, v228, v229
    ds_write_b16 v146, v190 offset:2
    ds_write_b16_d16_hi v146, v190 offset:2050
    v_mov_b32 v198, v184
    s_mov_b64 exec, s[52:53]
    v_pk_fma_f32 v[196:197], v[208:209], v[140:141], v[212:213] neg_lo:[0,0,1] neg_hi:[0,0,1]
    v_fma_f32 v219, v202, v142, -v214
    v_pk_add_f32 v[196:197], v[196:197], v[196:197] op_sel:[0,1] op_sel_hi:[0,1] neg_hi:[0,1]
    v_fmac_f32 v219, v203, v143
    v_cvt_pk_f16_f32 v198, v196, v197
    s_mov_b64 exec, s[50:51]
    v_pk_add_f32 v[218:219], v[218:219], v[218:219] op_sel:[0,1] op_sel_hi:[0,1] neg_hi:[0,1]
    v_pk_add_f32 v[222:223], v[222:223], v[222:223] op_sel:[0,1] op_sel_hi:[0,1] neg_hi:[0,1]
    v_pk_add_f32 v[226:227], v[226:227], v[226:227] op_sel:[0,1] op_sel_hi:[0,1] neg_hi:[0,1]
    v_pk_add_f32 v[230:231], v[230:231], v[230:231] op_sel:[0,1] op_sel_hi:[0,1] neg_hi:[0,1]
    s_mov_b64 exec, s[80:81]
    v_cvt_pk_f16_f32 v185, v218, v219
    v_cvt_pk_f16_f32 v187, v222, v223
    v_cvt_pk_f16_f32 v189, v226, v227
    v_cvt_pk_f16_f32 v191, v230, v231
    v_cndmask_b32_e64 v218, v185, v198, s[48:49]
    ds_write_b16 v147, v218
    s_cbranch_execz L_e0
    ds_write_b16_d16_hi v147, v218 offset:2048
    v_cndmask_b32_e64 v222, v187, v186, s[48:49]
    ds_write_b16 v148, v222
    ds_write_b16_d16_hi v148, v222 offset:2048
    v_cndmask_b32_e64 v226, v189, v188, s[48:49]
    ds_write_b16 v149, v226 offset:2
    ds_write_b16_d16_hi v149, v226 offset:2050
    v_cndmask_b32_e64 v230, v191, v190, s[48:49]
    ds_write_b16 v149, v230
    ds_write_b16_d16_hi v149, v230 offset:2048
    s_mov_b64 exec, s[48:49]
    ds_write_b16 v144, v185 offset:4096
    ds_write_b16_d16_hi v147, v185 offset:4096
    ds_write_b16 v145, v187 offset:4098
    ds_write_b16_d16_hi v148, v187 offset:4096
    ds_write_b16 v146, v189 offset:4096
    ds_write_b16_d16_hi v149, v189 offset:4098
    ds_write_b16 v146, v191 offset:4098
    ds_write_b16_d16_hi v149, v191 offset:4096
    s_mov_b64 exec, s[80:81]
    s_cmp_lg_u32 s47, 0
    s_cbranch_execz L_e0
    s_waitcnt lgkmcnt(0)
    s_barrier
    s_cbranch_scc1 L_xfft
    ds_read_b128 v[248:251], v154 offset:4096
    ds_read_b128 v[252:255], v154 offset:5120
    ds_read_b128 v[184:187], v154
    ds_read_b128 v[188:191], v154 offset:2048
    ds_read_b128 v[192:195], v154 offset:1024
    ds_read_b128 v[196:199], v154 offset:3072
    s_cmp_lg_u32 s14, 0
    s_cbranch_scc1 L_noflw
    v_bfe_u32 v232, v152, 8, 7
    v_bfe_u32 v233, v152, 4, 1
    v_lshl_or_b32 v232, v233, 7, v232
    v_lshlrev_b32 v232, 2, v232
    global_load_dword v1, v232, s[28:29] sc1
L_noflw:
    s_waitcnt lgkmcnt(5)
    v_mfma_f32_16x16x32_f16 v[232:235], v[248:251], v[34:37], 0
    v_mfma_f32_16x16x32_f16 v[236:239], v[248:251], v[38:41], 0
    s_waitcnt lgkmcnt(4)
    v_mfma_f32_16x16x32_f16 v[240:243], v[252:255], v[34:37], 0
    v_mfma_f32_16x16x32_f16 v[244:247], v[252:255], v[38:41], 0
    s_waitcnt lgkmcnt(3)
    v_mfma_f32_16x16x32_f16 v[200:203], v[184:187], v[34:37], 0
    v_mfma_f32_16x16x32_f16 v[204:207], v[184:187], v[38:41], 0
    s_waitcnt lgkmcnt(2)
    s_cbranch_execz L_e0
    v_mfma_f32_16x16x32_f16 v[208:211], v[188:191], v[34:37], 0
    v_mfma_f32_16x16x32_f16 v[212:215], v[188:191], v[38:41], 0
    s_waitcnt lgkmcnt(1)
    v_mfma_f32_16x16x32_f16 v[216:219], v[192:195], v[34:37], 0
    v_mfma_f32_16x16x32_f16 v[220:223], v[192:195], v[38:41], 0
    s_waitcnt lgkmcnt(0)
    v_mfma_f32_16x16x32_f16 v[224:227], v[196:199], v[34:37], 0
    v_mfma_f32_16x16x32_f16 v[228:231], v[196:199], v[38:41], 0
    v_pk_mul_f32 v[248:249], v[200:201], v[2:3]
    v_pk_mul_f32 v[252:253], v[204:205], v[2:3]
    v_pk_fma_f32 v[248:249], v[204:205], v[10:11], v[248:249]
    v_pk_fma_f32 v[252:253], v[200:201], v[10:11], v[252:253] neg_lo:[1,0,0] neg_hi:[1,0,0]
    v_pk_mul_f32 v[200:201], v[232:233], v[2:3]
    v_pk_mul_f32 v[204:205], v[236:237], v[2:3]
    v_pk_fma_f32 v[248:249], v[208:209], v[18:19], v[248:249]
    v_pk_fma_f32 v[252:253], v[212:213], v[18:19], v[252:253]
    v_pk_fma_f32 v[200:201], v[236:237], v[10:11], v[200:201]
    v_pk_fma_f32 v[204:205], v[232:233], v[10:11], v[204:205] neg_lo:[1,0,0] neg_hi:[1,0,0]
    v_pk_fma_f32 v[248:249], v[212:213], v[26:27], v[248:249]
    v_pk_fma_f32 v[252:253], v[208:209], v[26:27], v[252:253] neg_lo:[1,0,0] neg_hi:[1,0,0]
    v_pk_mul_f32 v[250:251], v[202:203], v[4:5]
    v_pk_mul_f32 v[254:255], v[206:207], v[4:5]
    v_pk_fma_f32 v[250:251], v[206:207], v[12:13], v[250:251]
    v_pk_fma_f32 v[254:255], v[202:203], v[12:13], v[254:255] neg_lo:[1,0,0] neg_hi:[1,0,0]
    v_pk_mul_f32 v[202:203], v[234:235], v[4:5]
    v_pk_mul_f32 v[206:207], v[238:239], v[4:5]
    v_pk_fma_f32 v[250:251], v[210:211], v[20:21], v[250:251]
    v_pk_fma_f32 v[254:255], v[214:215], v[20:21], v[254:255]
    v_pk_fma_f32 v[202:203], v[238:239], v[12:13], v[202:203]
    v_pk_fma_f32 v[206:207], v[234:235], v[12:13], v[206:207] neg_lo:[1,0,0] neg_hi:[1,0,0]
    v_pk_fma_f32 v[250:251], v[214:215], v[28:29], v[250:251]
    v_pk_fma_f32 v[254:255], v[210:211], v[28:29], v[254:255] neg_lo:[1,0,0] neg_hi:[1,0,0]
    v_cvt_pk_f16_f32 v192, v200, v204
    v_cvt_pk_f16_f32 v193, v201, v205
    v_cvt_pk_f16_f32 v194, v202, v206
    v_cvt_pk_f16_f32 v195, v203, v207
    v_cvt_pk_f16_f32 v184, v248, v252
    v_cvt_pk_f16_f32 v185, v249, v253
    v_cvt_pk_f16_f32 v186, v250, v254
    v_cvt_pk_f16_f32 v187, v251, v255
    v_pk_mul_f32 v[248:249], v[216:217], v[6:7]
    v_pk_mul_f32 v[252:253], v[220:221], v[6:7]
    v_pk_fma_f32 v[248:249], v[220:221], v[14:15], v[248:249]
    s_cbranch_execz L_e0
    v_pk_fma_f32 v[252:253], v[216:217], v[14:15], v[252:253] neg_lo:[1,0,0] neg_hi:[1,0,0]
    v_pk_mul_f32 v[216:217], v[240:241], v[6:7]
    v_pk_mul_f32 v[220:221], v[244:245], v[6:7]
    v_pk_fma_f32 v[248:249], v[224:225], v[22:23], v[248:249]
    v_pk_fma_f32 v[252:253], v[228:229], v[22:23], v[252:253]
    v_pk_fma_f32 v[216:217], v[244:245], v[14:15], v[216:217]
    v_pk_fma_f32 v[220:221], v[240:241], v[14:15], v[220:221] neg_lo:[1,0,0] neg_hi:[1,0,0]
    v_pk_fma_f32 v[248:249], v[228:229], v[30:31], v[248:249]
    v_pk_fma_f32 v[252:253], v[224:225], v[30:31], v[252:253] neg_lo:[1,0,0] neg_hi:[1,0,0]
    v_pk_mul_f32 v[250:251], v[218:219], v[8:9]
    v_pk_mul_f32 v[254:255], v[222:223], v[8:9]
    v_pk_fma_f32 v[250:251], v[222:223], v[16:17], v[250:251]
    v_pk_fma_f32 v[254:255], v[218:219], v[16:17], v[254:255] neg_lo:[1,0,0] neg_hi:[1,0,0]
    v_pk_mul_f32 v[218:219], v[242:243], v[8:9]
    v_pk_mul_f32 v[222:223], v[246:247], v[8:9]
    v_pk_fma_f32 v[250:251], v[226:227], v[24:25], v[250:251]
    v_pk_fma_f32 v[254:255], v[230:231], v[24:25], v[254:255]
    v_pk_fma_f32 v[218:219], v[246:247], v[16:17], v[218:219]
    v_pk_fma_f32 v[222:223], v[242:243], v[16:17], v[222:223] neg_lo:[1,0,0] neg_hi:[1,0,0]
    v_pk_fma_f32 v[250:251], v[230:231], v[32:33], v[250:251]
    v_pk_fma_f32 v[254:255], v[226:227], v[32:33], v[254:255] neg_lo:[1,0,0] neg_hi:[1,0,0]
    v_cvt_pk_f16_f32 v196, v216, v220
    v_cvt_pk_f16_f32 v197, v217, v221
    v_cvt_pk_f16_f32 v198, v218, v222
    v_cvt_pk_f16_f32 v199, v219, v223
    v_cvt_pk_f16_f32 v188, v248, v252
    v_cvt_pk_f16_f32 v189, v249, v253
    v_cvt_pk_f16_f32 v190, v250, v254
    v_cvt_pk_f16_f32 v191, v251, v255
    s_nop 0
    s_branch L_x2
L_w0fin:
    v_pk_fma_f32 v[200:201], v[90:91], s[60:61], v[106:107]
    v_pk_fma_f32 v[216:217], v[90:91], s[60:61], v[106:107] neg_lo:[0,0,1] neg_hi:[0,0,1]
    v_cvt_pk_bf16_f32 v184, v200, v201
    v_cvt_pk_bf16_f32 v192, v216, v217
    v_pk_fma_f32 v[202:203], v[92:93], s[60:61], v[108:109]
    v_pk_fma_f32 v[218:219], v[92:93], s[60:61], v[108:109] neg_lo:[0,0,1] neg_hi:[0,0,1]
    v_cvt_pk_bf16_f32 v185, v202, v203
    v_cvt_pk_bf16_f32 v193, v218, v219
    v_pk_fma_f32 v[204:205], v[94:95], s[60:61], v[110:111]
    v_pk_fma_f32 v[220:221], v[94:95], s[60:61], v[110:111] neg_lo:[0,0,1] neg_hi:[0,0,1]
    v_cvt_pk_bf16_f32 v186, v204, v205
    s_cbranch_execz L_e0
    v_cvt_pk_bf16_f32 v194, v220, v221
    v_pk_fma_f32 v[206:207], v[96:97], s[60:61], v[112:113]
    v_pk_fma_f32 v[222:223], v[96:97], s[60:61], v[112:113] neg_lo:[0,0,1] neg_hi:[0,0,1]
    v_cvt_pk_bf16_f32 v187, v206, v207
    v_cvt_pk_bf16_f32 v195, v222, v223
    v_pk_fma_f32 v[208:209], v[98:99], s[60:61], v[114:115]
    v_pk_fma_f32 v[224:225], v[98:99], s[60:61], v[114:115] neg_lo:[0,0,1] neg_hi:[0,0,1]
    v_cvt_pk_bf16_f32 v188, v208, v209
    v_cvt_pk_bf16_f32 v196, v224, v225
    v_pk_fma_f32 v[210:211], v[100:101], s[60:61], v[116:117]
    v_pk_fma_f32 v[226:227], v[100:101], s[60:61], v[116:117] neg_lo:[0,0,1] neg_hi:[0,0,1]
    v_cvt_pk_bf16_f32 v189, v210, v211
    v_cvt_pk_bf16_f32 v197, v226, v227
    v_pk_fma_f32 v[212:213], v[102:103], s[60:61], v[118:119]
    v_pk_fma_f32 v[228:229], v[102:103], s[60:61], v[118:119] neg_lo:[0,0,1] neg_hi:[0,0,1]
    v_cvt_pk_bf16_f32 v190, v212, v213
    v_cvt_pk_bf16_f32 v198, v228, v229
    v_pk_fma_f32 v[214:215], v[104:105], s[60:61], v[120:121]
    v_pk_fma_f32 v[230:231], v[104:105], s[60:61], v[120:121] neg_lo:[0,0,1] neg_hi:[0,0,1]
    v_cvt_pk_bf16_f32 v191, v214, v215
    v_cvt_pk_bf16_f32 v199, v230, v231
    s_mov_b64 exec, s[50:51]
    ds_write_b16 v176, v184 offset:6144
    ds_write_b16_d16_hi v176, v184 offset:8448
    ds_write_b16 v178, v192 offset:13056
    ds_write_b16_d16_hi v178, v192 offset:10752
    ds_write_b16 v177, v185 offset:6144
    ds_write_b16_d16_hi v177, v185 offset:8448
    ds_write_b16 v175, v193 offset:13056
    ds_write_b16_d16_hi v175, v193 offset:10752
    ds_write_b16 v175, v186 offset:6208
    ds_write_b16_d16_hi v175, v186 offset:8512
    ds_write_b16 v180, v194 offset:13664
    ds_write_b16_d16_hi v180, v194 offset:11360
    ds_write_b16 v180, v187 offset:6752
    ds_write_b16_d16_hi v180, v187 offset:9056
    ds_write_b16 v175, v195 offset:13120
    ds_write_b16_d16_hi v175, v195 offset:10816
    ds_write_b16 v175, v188 offset:6720
    ds_write_b16_d16_hi v175, v188 offset:9024
    ds_write_b16 v179, v196 offset:13056
    ds_write_b16_d16_hi v179, v196 offset:10752
    ds_write_b16 v179, v189 offset:6144
    ds_write_b16_d16_hi v179, v189 offset:8448
    ds_write_b16 v175, v197 offset:13632
    ds_write_b16_d16_hi v175, v197 offset:11328
    ds_write_b16 v175, v190 offset:6784
    ds_write_b16_d16_hi v175, v190 offset:9088
    ds_write_b16 v180, v198 offset:13088
    ds_write_b16_d16_hi v180, v198 offset:10784
    ds_write_b16 v180, v191 offset:6176
    ds_write_b16_d16_hi v180, v191 offset:8480
    ds_write_b16 v175, v199 offset:13696
    ds_write_b16_d16_hi v175, v199 offset:11392
    s_mov_b64 exec, s[48:49]
    ds_write_b16 v176, v184 offset:6144
    ds_write_b16_d16_hi v176, v184 offset:8448
    ds_write_b16 v178, v192 offset:6144
    ds_write_b16_d16_hi v178, v192 offset:8448
    ds_write_b16 v178, v185 offset:10752
    ds_write_b16_d16_hi v176, v185 offset:10752
    ds_write_b16 v176, v193 offset:13056
    ds_write_b16_d16_hi v178, v193 offset:13056
    ds_write_b16 v175, v186 offset:6208
    ds_write_b16_d16_hi v175, v186 offset:8512
    ds_write_b16 v180, v194 offset:6752
    ds_write_b16_d16_hi v180, v194 offset:9056
    ds_write_b16 v180, v187 offset:11360
    ds_write_b16_d16_hi v175, v187 offset:10816
    ds_write_b16 v175, v195 offset:13120
    ds_write_b16_d16_hi v180, v195 offset:13664
    ds_write_b16 v175, v188 offset:6720
    ds_write_b16_d16_hi v175, v188 offset:9024
    ds_write_b16 v179, v196 offset:6144
    ds_write_b16_d16_hi v179, v196 offset:8448
    ds_write_b16 v179, v189 offset:10752
    ds_write_b16_d16_hi v175, v189 offset:11328
    ds_write_b16 v175, v197 offset:13632
    ds_write_b16_d16_hi v179, v197 offset:13056
    ds_write_b16 v175, v190 offset:6784
    ds_write_b16_d16_hi v175, v190 offset:9088
    ds_write_b16 v180, v198 offset:6176
    ds_write_b16_d16_hi v180, v198 offset:8480
    ds_write_b16 v180, v191 offset:10784
    ds_write_b16_d16_hi v175, v191 offset:11392
    ds_write_b16 v175, v199 offset:13696
    ds_write_b16_d16_hi v180, v199 offset:13088
    s_mov_b64 exec, s[80:81]
    s_cmp_lg_u32 s12, 0
    s_cbranch_scc1 L_fin2
    v_mov_b32 v204, 0x40000
    v_mov_b32 v205, s17
    s_mov_b64 exec, s[82:83]
    global_store_dword v204, v205, s[28:29] sc1
    s_mov_b64 exec, s[80:81]
    s_branch L_fin2

.section .rodata,"a"
.p2align 6
.amdhsa_kernel interleave_layers__spectral_fnet__spectral_fnet__prompt_kernel
  .amdhsa_next_free_vgpr 256
  .amdhsa_next_free_sgpr 96
  .amdhsa_accum_offset 256
  .amdhsa_group_segment_fixed_size 0
  .amdhsa_kernarg_size 104
  .amdhsa_user_sgpr_count 2
  .amdhsa_user_sgpr_kernarg_segment_ptr 1
  .amdhsa_system_sgpr_workgroup_id_x 1
.end_amdhsa_kernel
```
